```python
import torch

def _softmax(x, axis=-1):
    return torch.softmax(x, dim=axis)
def _gelu(x):
    return torch.nn.functional.gelu(x, approximate="tanh")
def _silu(x):
    return torch.nn.functional.silu(x)
def _sigmoid(x):
    return torch.sigmoid(x)
def _layernorm(x, axis=-1, eps=1e-5):
    m = x.mean(dim=axis, keepdim=True)
    v = x.var(dim=axis, keepdim=True, unbiased=False)
    return (x - m) / torch.sqrt(v + eps)
def _scatter_add(tgt, idx, src, axis=0):
    return tgt.clone().index_add_(axis, idx, src)
def _segment_sum(src, seg, n):
    out = torch.zeros((n,) + src.shape[1:], dtype=src.dtype)
    return out.index_add_(0, seg, src)
def _pad(x, pw):
    flat = tuple(v for pair in reversed(pw) for v in pair)
    return torch.nn.functional.pad(x, flat)

kernel_name = 'gated_mix__mha_block__glu_gated_geglu__prompt'

def setup_inputs():

    _w = (lambda a: (lambda t: t.to(torch.bfloat16) if t.is_floating_point() else t)(torch.as_tensor(a)))
    def _A_setup():
        B, S, D, H = 1, 2048, 512, 32
        return {
            "x": _w((lambda *s: torch.randn(*s, dtype=torch.bfloat16) * 0.05)(B, S, D)),
            "wqkv": _w((lambda *s: torch.randn(*s, dtype=torch.bfloat16) * 0.8)(D, 3 * D)),
            "wo": _w((lambda *s: torch.randn(*s, dtype=torch.bfloat16) * 0.05)(D, D)),
        }
    _A_in = _A_setup()

    def _B_setup():
        B, S, Dm, Df = 1, 2048, 512, 1376
        return {
            "x": _w((lambda *s: torch.randn(*s, dtype=torch.bfloat16) * 0.05)(B, S, Dm)),
            "w_gate": _w((lambda *s: torch.randn(*s, dtype=torch.bfloat16) * 3.2)(Dm, Df) * (Dm ** -0.5)),
            "w_up": _w((lambda *s: torch.randn(*s, dtype=torch.bfloat16) * 3.2)(Dm, Df) * (Dm ** -0.5)),
            "w_down": _w((lambda *s: torch.randn(*s, dtype=torch.bfloat16) * 3.2)(Df, Dm) * (Df ** -0.5)),
        }
    _B_in = _B_setup()

    return {
        "A_x": _A_in["x"],
        "A_wqkv": _A_in["wqkv"],
        "A_wo": _A_in["wo"],
        "B_x": _B_in["x"],
        "B_w_gate": _B_in["w_gate"],
        "B_w_up": _B_in["w_up"],
        "B_w_down": _B_in["w_down"],
        "gate_w": _w((lambda *s: torch.randn(*s, dtype=torch.bfloat16) * 0.05)(512) * 16.0),
    }

def reference(A_x, A_wqkv, A_wo, B_x, B_w_gate, B_w_up, B_w_down, gate_w):
    def _A_ref(x, wqkv, wo):
        B, S, D = x.shape
        H = 32
        Dh = D // H
        qkv = (lambda x, *d: x.permute(*d))((x @ wqkv).reshape(B, S, 3, H, Dh), 2, 0, 3, 1, 4)
        q, k, v = qkv[0], qkv[1], qkv[2]
        scores = torch.einsum("bhqd,bhkd->bhqk", q, k) * (Dh ** -0.5)
        p = _softmax(scores, axis=-1)
        o = torch.einsum("bhqk,bhkd->bhqd", p, v)
        return (lambda x, *d: x.permute(*d))(o, 0, 2, 1, 3).reshape(B, S, D) @ wo

    def _B_ref(x, w_gate, w_up, w_down):
        g = torch.einsum("bsd,df->bsf", x, w_gate)
        u = torch.einsum("bsd,df->bsf", x, w_up)
        h = _gelu(g) * u
        return torch.einsum("bsf,fd->bsd", h, w_down)

    x = A_x
    g = _sigmoid((x * gate_w).sum(-1, keepdims=True))
    a = _A_ref(x, A_wqkv, A_wo)
    b = _B_ref(x, B_w_gate, B_w_up, B_w_down)
    return g * a + (1 - g) * b
```

```asm
; @launch grid=(256,1,1) block=(512,1,1) lds=163840
.amdgcn_target "amdgcn-amd-amdhsa--gfx950"
.text
.globl gated_mix__mha_block__glu_gated_geglu__prompt_kernel
.p2align 8
.type gated_mix__mha_block__glu_gated_geglu__prompt_kernel,@function
gated_mix__mha_block__glu_gated_geglu__prompt_kernel:
    s_cmp_ge_u32 s2, 256
    s_cbranch_scc1 K_END
    s_getpc_b64 s[50:51]
CODE_REF0:
    s_lshr_b32 s48, s2, 3
    v_lshrrev_b32 v3, 5, v0
    s_lshl_b32 s48, s48, 4
    s_sub_u32 s50, s50, CODE_REF0 - gated_mix__mha_block__glu_gated_geglu__prompt_kernel
    v_add_u32 v3, s48, v3
    s_subb_u32 s51, s51, 0
    v_lshlrev_b32 v3, 7, v3
    v_min_u32 v3, CODE_BYTES - 4, v3
    global_load_dword v30, v3, s[50:51]
    s_load_dwordx16 s[64:79], s[0:1], 0
    s_load_dwordx4 s[80:83], s[0:1], 64
    s_load_dwordx2 s[84:85], s[0:1], 80
    v_lshrrev_b32 v3, 6, v0
    v_and_b32 v1, 63, v0
    v_readfirstlane_b32 s24, v3
    v_lshlrev_b32 v2, 4, v1
    s_nop 0
    s_and_b32 s25, s24, 3
    s_and_b32 s48, s2, 7
    s_lshr_b32 s49, s2, 3
    s_lshr_b32 s26, s48, 1
    s_lshl_b32 s26, s26, 3
    s_and_b32 s50, s49, 7
    s_add_u32 s26, s26, s50
    s_and_b32 s27, s48, 1
    s_lshl_b32 s27, s27, 2
    s_lshr_b32 s50, s49, 3
    s_add_u32 s27, s27, s50
    s_lshl_b32 s50, s50, 1
    s_add_u32 s28, s49, s50
    s_and_b32 s28, s28, 7
    s_lshl_b32 s29, s26, 16
    s_lshl_b32 s30, s27, 7
    s_lshl_b32 s31, s25, 11
    s_lshr_b32 s32, s48, 1
    s_lshl_b32 s32, s32, 2
    s_and_b32 s50, s49, 3
    s_add_u32 s32, s32, s50
    s_and_b32 s33, s48, 1
    s_lshl_b32 s33, s33, 3
    s_lshr_b32 s51, s49, 2
    s_add_u32 s33, s33, s51
    s_lshl_b32 s50, s50, 1
    s_add_u32 s34, s51, s50
    s_and_b32 s34, s34, 7
    s_lshl_b32 s35, s32, 17
    s_mul_i32 s36, s33, 192
    s_lshl_b32 s37, s25, 12
    s_mul_i32 s38, s25, 3072
    s_add_u32 s38, s38, 16384
    s_lshl_b32 s57, s48, 2
    s_and_b32 s50, s49, 3
    s_add_u32 s57, s57, s50
    s_lshr_b32 s58, s49, 2
    s_cmp_ge_u32 s24, 4
    s_cbranch_scc1 K_B
    s_lshr_b32 s49, s25, 1
    v_and_b32 v3, 31, v1
    s_lshl_b32 s48, s49, 5
    v_add_u32 v3, s48, v3
    v_lshrrev_b32 v4, 1, v3
    v_and_b32 v4, 7, v4
    v_lshrrev_b32 v5, 5, v1
    v_xor_b32 v4, v4, v5
    v_lshlrev_b32 v3, 7, v3
    v_xor_b32 v5, 0, v4
    v_lshlrev_b32 v5, 4, v5
    v_add_u32 v24, v3, v5
    v_xor_b32 v5, 2, v4
    v_lshlrev_b32 v5, 4, v5
    v_add_u32 v25, v3, v5
    v_xor_b32 v5, 4, v4
    v_lshlrev_b32 v5, 4, v5
    v_add_u32 v26, v3, v5
    v_xor_b32 v5, 6, v4
    v_lshlrev_b32 v5, 4, v5
    v_add_u32 v27, v3, v5
    v_and_b32 v3, 15, v1
    v_lshrrev_b32 v3, 2, v3
    v_lshrrev_b32 v4, 5, v1
    v_lshlrev_b32 v4, 3, v4
    v_add_u32 v4, v4, v3
    v_mul_u32_u24 v4, 128, v4
    v_lshrrev_b32 v3, 1, v3
    s_and_b32 s50, s25, 1
    v_xor_b32 v3, s50, v3
    v_lshlrev_b32 v3, 6, v3
    v_add_u32 v4, v4, v3
    v_lshrrev_b32 v3, 4, v1
    v_and_b32 v3, 1, v3
    v_lshlrev_b32 v3, 5, v3
    v_add_u32 v4, v4, v3
    v_and_b32 v3, 3, v1
    v_lshlrev_b32 v3, 3, v3
    v_add_u32 v4, v4, v3
    v_add_u32 v28, 8192, v4
    v_accvgpr_write_b32 a0, 0
    v_accvgpr_write_b32 a1, 0
    v_accvgpr_write_b32 a2, 0
    v_accvgpr_write_b32 a3, 0
    v_accvgpr_write_b32 a4, 0
    v_accvgpr_write_b32 a5, 0
    v_accvgpr_write_b32 a6, 0
    v_accvgpr_write_b32 a7, 0
    v_accvgpr_write_b32 a8, 0
    v_accvgpr_write_b32 a9, 0
    v_accvgpr_write_b32 a10, 0
    v_accvgpr_write_b32 a11, 0
    v_accvgpr_write_b32 a12, 0
    v_accvgpr_write_b32 a13, 0
    v_accvgpr_write_b32 a14, 0
    v_accvgpr_write_b32 a15, 0
    v_accvgpr_write_b32 a16, 0
    v_accvgpr_write_b32 a17, 0
    v_accvgpr_write_b32 a18, 0
    v_accvgpr_write_b32 a19, 0
    v_accvgpr_write_b32 a20, 0
    v_accvgpr_write_b32 a21, 0
    v_accvgpr_write_b32 a22, 0
    v_accvgpr_write_b32 a23, 0
    v_accvgpr_write_b32 a24, 0
    v_accvgpr_write_b32 a25, 0
    v_accvgpr_write_b32 a26, 0
    v_accvgpr_write_b32 a27, 0
    v_accvgpr_write_b32 a28, 0
    v_accvgpr_write_b32 a29, 0
    v_accvgpr_write_b32 a30, 0
    v_accvgpr_write_b32 a31, 0
    v_accvgpr_write_b32 a32, 0
    v_accvgpr_write_b32 a33, 0
    v_accvgpr_write_b32 a34, 0
    v_accvgpr_write_b32 a35, 0
    v_accvgpr_write_b32 a36, 0
    v_accvgpr_write_b32 a37, 0
    v_accvgpr_write_b32 a38, 0
    v_accvgpr_write_b32 a39, 0
    v_accvgpr_write_b32 a40, 0
    v_accvgpr_write_b32 a41, 0
    v_accvgpr_write_b32 a42, 0
    v_accvgpr_write_b32 a43, 0
    v_accvgpr_write_b32 a44, 0
    v_accvgpr_write_b32 a45, 0
    v_accvgpr_write_b32 a46, 0
    v_accvgpr_write_b32 a47, 0
    s_mov_b32 s41, 0
    v_add_u32 v144, s41, v24
    v_add_u32 v145, s41, v25
    v_add_u32 v146, s41, v26
    v_add_u32 v147, s41, v27
    v_add_u32 v148, s41, v28
    v_lshrrev_b32 v3, 3, v1
    s_mul_i32 s48, s25, 32
    s_add_u32 s48, s48, 0
    v_add_u32 v3, s48, v3
    v_lshrrev_b32 v4, 1, v3
    v_and_b32 v4, 7, v4
    v_and_b32 v5, 7, v1
    v_xor_b32 v4, v4, v5
    v_lshlrev_b32 v4, 4, v4
    v_lshlrev_b32 v3, 10, v3
    v_add_u32 v17, v3, v4
    v_lshrrev_b32 v3, 3, v1
    s_mul_i32 s48, s25, 32
    s_add_u32 s48, s48, 8
    v_add_u32 v3, s48, v3
    v_lshrrev_b32 v4, 1, v3
    v_and_b32 v4, 7, v4
    v_and_b32 v5, 7, v1
    v_xor_b32 v4, v4, v5
    v_lshlrev_b32 v4, 4, v4
    v_lshlrev_b32 v3, 10, v3
    v_add_u32 v18, v3, v4
    v_lshrrev_b32 v3, 3, v1
    s_mul_i32 s48, s25, 32
    s_add_u32 s48, s48, 16
    v_add_u32 v3, s48, v3
    v_lshrrev_b32 v4, 1, v3
    v_and_b32 v4, 7, v4
    v_and_b32 v5, 7, v1
    v_xor_b32 v4, v4, v5
    v_lshlrev_b32 v4, 4, v4
    v_lshlrev_b32 v3, 10, v3
    v_add_u32 v19, v3, v4
    v_lshrrev_b32 v3, 3, v1
    s_mul_i32 s48, s25, 32
    s_add_u32 s48, s48, 24
    v_add_u32 v3, s48, v3
    v_lshrrev_b32 v4, 1, v3
    v_and_b32 v4, 7, v4
    v_and_b32 v5, 7, v1
    v_xor_b32 v4, v4, v5
    v_lshlrev_b32 v4, 4, v4
    v_lshlrev_b32 v3, 10, v3
    v_add_u32 v20, v3, v4
    v_add_u32 v3, 0, v1
    v_mul_u32_u24 v4, 171, v3
    v_lshrrev_b32 v4, 11, v4
    v_mul_u32_u24 v5, 12, v4
    v_sub_u32 v5, v3, v5
    s_lshl_b32 s48, s25, 4
    v_add_u32 v4, s48, v4
    v_mul_u32_u24 v4, 2752, v4
    v_lshlrev_b32 v5, 4, v5
    v_add_u32 v21, v4, v5
    v_add_u32 v3, 64, v1
    v_mul_u32_u24 v4, 171, v3
    v_lshrrev_b32 v4, 11, v4
    v_mul_u32_u24 v5, 12, v4
    v_sub_u32 v5, v3, v5
    s_lshl_b32 s48, s25, 4
    v_add_u32 v4, s48, v4
    v_mul_u32_u24 v4, 2752, v4
    v_lshlrev_b32 v5, 4, v5
    v_add_u32 v22, v4, v5
    v_add_u32 v3, 128, v1
    v_mul_u32_u24 v4, 171, v3
    v_lshrrev_b32 v4, 11, v4
    v_mul_u32_u24 v5, 12, v4
    v_sub_u32 v5, v3, v5
    s_lshl_b32 s48, s25, 4
    v_add_u32 v4, s48, v4
    v_mul_u32_u24 v4, 2752, v4
    v_lshlrev_b32 v5, 4, v5
    v_add_u32 v23, v4, v5
    s_waitcnt lgkmcnt(0)
    s_mov_b32 s4, s64
    s_mov_b32 s5, s65
    s_mov_b32 s6, 0x200000
    s_mov_b32 s7, 0x00020000
    s_mov_b32 s8, s66
    s_mov_b32 s9, s67
    s_mov_b32 s10, 0x180000
    s_mov_b32 s11, 0x00020000
    s_mov_b32 s12, s72
    s_mov_b32 s13, s73
    s_mov_b32 s14, 0x158000
    s_mov_b32 s15, 0x00020000
    s_mov_b32 s16, s74
    s_mov_b32 s17, s75
    s_mov_b32 s18, 0x158000
    s_mov_b32 s19, 0x00020000
    s_mov_b32 s20, s84
    s_mov_b32 s21, s85
    s_mov_b32 s22, 0x1800000
    s_mov_b32 s23, 0x00020000
    s_cmp_lg_u32 s2, 0
    s_cbranch_scc1 NONCE_SKIP
    s_cmp_lg_u32 s24, 0
    s_cbranch_scc1 NONCE_SKIP
    s_memrealtime s[48:49]
    s_waitcnt lgkmcnt(0)
    s_or_b32 s48, s48, 1
    v_mov_b32 v3, s48
    v_mov_b32 v4, 0
    s_mov_b64 exec, 1
    global_store_dword v4, v3, s[82:83] sc1
    s_mov_b64 exec, -1
NONCE_SKIP:
    s_and_b32 s48, s2, 7
    s_lshr_b32 s49, s2, 3
    s_lshl_b32 s70, s48, 2
    s_and_b32 s50, s49, 3
    s_add_u32 s70, s70, s50
    s_lshr_b32 s71, s49, 2
    v_lshrrev_b32 v3, 3, v1
    v_lshlrev_b32 v3, 10, v3
    v_lshrrev_b32 v4, 4, v1
    v_and_b32 v4, 1, v4
    v_lshlrev_b32 v4, 2, v4
    v_and_b32 v5, 7, v1
    v_xor_b32 v4, v4, v5
    v_lshlrev_b32 v4, 4, v4
    v_add_u32 v7, v3, v4
    s_lshl_b32 s66, s24, 13
    s_add_u32 s66, s66, 73728
    v_and_b32 v3, 15, v1
    v_lshrrev_b32 v3, 2, v3
    v_lshrrev_b32 v4, 5, v1
    v_lshlrev_b32 v4, 2, v4
    v_add_u32 v4, v4, v3
    v_lshlrev_b32 v4, 7, v4
    v_lshrrev_b32 v3, 1, v3
    v_lshlrev_b32 v3, 6, v3
    v_add_u32 v4, v4, v3
    v_lshrrev_b32 v3, 4, v1
    v_and_b32 v3, 1, v3
    v_lshlrev_b32 v3, 5, v3
    v_add_u32 v4, v4, v3
    v_and_b32 v3, 3, v1
    v_lshlrev_b32 v3, 3, v3
    v_add_u32 v4, v4, v3
    v_add_u32 v8, s66, v4
    v_xor_b32 v9, 64, v8
    s_lshl_b32 s48, s70, 1
    s_and_b32 s49, s24, 1
    s_add_u32 s48, s48, s49
    s_mul_i32 s48, s48, 86
    s_lshr_b32 s49, s24, 1
    s_mul_i32 s49, s49, 22
    s_add_u32 s48, s48, s49
    s_lshl_b32 s72, s48, 10
    s_lshl_b32 s73, s49, 14
    s_lshl_b32 s50, s71, 7
    s_add_u32 s73, s73, s50
    s_add_u32 s74, s73, 8192
    s_lshl_b32 s75, s70, 7
    s_add_u32 s75, s75, 0xe11000
    v_and_b32 v11, 31, v1
    v_lshlrev_b32 v11, 2, v11
    s_lshl_b32 s48, s25, 3
    s_lshr_b32 s49, s24, 2
    s_lshl_b32 s49, s49, 2
    s_add_u32 s48, s48, s49
    s_mul_i32 s48, s48, 2304
    v_add_u32 v6, s48, v2
    v_lshlrev_b32 v0, 2, v1
    v_add_u32 v0, s48, v0
    s_add_u32 s34, s34, 2
    s_and_b32 s34, s34, 7
    s_mov_b32 s40, 81920
    s_barrier
    ds_read_b128 v[32:35], v144
    ds_read_b64_tr_b16 v[36:37], v148 offset:0
    ds_read_b64_tr_b16 v[38:39], v148 offset:512
    ds_read_b64_tr_b16 v[40:41], v148 offset:8192
    ds_read_b64_tr_b16 v[42:43], v148 offset:8704
    ds_read_b64_tr_b16 v[44:45], v148 offset:16384
    ds_read_b64_tr_b16 v[46:47], v148 offset:16896
    ds_read_b128 v[48:51], v145
    ds_read_b64_tr_b16 v[52:53], v148 offset:2048
    ds_read_b64_tr_b16 v[54:55], v148 offset:2560
    ds_read_b64_tr_b16 v[56:57], v148 offset:10240
    ds_read_b64_tr_b16 v[58:59], v148 offset:10752
    ds_read_b64_tr_b16 v[60:61], v148 offset:18432
    ds_read_b64_tr_b16 v[62:63], v148 offset:18944
    s_mov_b32 s39, 0
P1_L:
    s_waitcnt lgkmcnt(7)
    v_mfma_f32_32x32x16_bf16 a[0:15], v[36:39], v[32:35], a[0:15]
    ds_read_b128 v[64:67], v146
    ds_read_b64_tr_b16 v[68:69], v148 offset:4096
    v_mfma_f32_32x32x16_bf16 a[16:31], v[40:43], v[32:35], a[16:31]
    ds_read_b64_tr_b16 v[70:71], v148 offset:4608
    ds_read_b64_tr_b16 v[72:73], v148 offset:12288
    v_mfma_f32_32x32x16_bf16 a[32:47], v[32:35], v[44:47], a[32:47]
    ds_read_b64_tr_b16 v[74:75], v148 offset:12800
    ds_read_b64_tr_b16 v[76:77], v148 offset:20480
    ds_read_b64_tr_b16 v[78:79], v148 offset:20992
    s_waitcnt lgkmcnt(7)
    v_mfma_f32_32x32x16_bf16 a[0:15], v[52:55], v[48:51], a[0:15]
    ds_read_b128 v[80:83], v147
    ds_read_b64_tr_b16 v[84:85], v148 offset:6144
    v_mfma_f32_32x32x16_bf16 a[16:31], v[56:59], v[48:51], a[16:31]
    ds_read_b64_tr_b16 v[86:87], v148 offset:6656
    ds_read_b64_tr_b16 v[88:89], v148 offset:14336
    v_mfma_f32_32x32x16_bf16 a[32:47], v[48:51], v[60:63], a[32:47]
    ds_read_b64_tr_b16 v[90:91], v148 offset:14848
    ds_read_b64_tr_b16 v[92:93], v148 offset:22528
    ds_read_b64_tr_b16 v[94:95], v148 offset:23040
    s_barrier
    s_add_u32 s41, s41, 40960
    s_cmp_eq_u32 s41, 163840
    s_cselect_b32 s41, 0, s41
    v_add_u32 v144, s41, v24
    v_add_u32 v145, s41, v25
    v_add_u32 v146, s41, v26
    v_add_u32 v147, s41, v27
    v_add_u32 v148, s41, v28
    s_waitcnt lgkmcnt(7)
    v_mfma_f32_32x32x16_bf16 a[0:15], v[68:71], v[64:67], a[0:15]
    ds_read_b128 v[32:35], v144
    ds_read_b64_tr_b16 v[36:37], v148 offset:0
    v_mfma_f32_32x32x16_bf16 a[16:31], v[72:75], v[64:67], a[16:31]
    ds_read_b64_tr_b16 v[38:39], v148 offset:512
    ds_read_b64_tr_b16 v[40:41], v148 offset:8192
    v_mfma_f32_32x32x16_bf16 a[32:47], v[64:67], v[76:79], a[32:47]
    ds_read_b64_tr_b16 v[42:43], v148 offset:8704
    ds_read_b64_tr_b16 v[44:45], v148 offset:16384
    ds_read_b64_tr_b16 v[46:47], v148 offset:16896
    s_waitcnt lgkmcnt(7)
    v_mfma_f32_32x32x16_bf16 a[0:15], v[84:87], v[80:83], a[0:15]
    ds_read_b128 v[48:51], v145
    ds_read_b64_tr_b16 v[52:53], v148 offset:2048
    v_mfma_f32_32x32x16_bf16 a[16:31], v[88:91], v[80:83], a[16:31]
    ds_read_b64_tr_b16 v[54:55], v148 offset:2560
    ds_read_b64_tr_b16 v[56:57], v148 offset:10240
    v_mfma_f32_32x32x16_bf16 a[32:47], v[80:83], v[92:95], a[32:47]
    ds_read_b64_tr_b16 v[58:59], v148 offset:10752
    ds_read_b64_tr_b16 v[60:61], v148 offset:18432
    ds_read_b64_tr_b16 v[62:63], v148 offset:18944
    s_add_u32 s39, s39, 1
    s_cmp_lt_u32 s39, 8
    s_cbranch_scc1 P1_L
    s_waitcnt lgkmcnt(0)
    v_mov_b32 v5, 0
    global_load_dword v29, v5, s[82:83] sc1
    s_cmp_eq_u32 s33, 15
    s_cbranch_scc1 A_GATE
    s_lshl_b32 s42, s34, 7
    s_add_u32 s42, s42, s35
    s_mul_i32 s43, s34, 176128
    s_add_u32 s43, s43, s36
    s_add_u32 s45, s40, s37
    s_add_u32 s46, s40, s38
    s_add_u32 s34, s34, 1
    s_and_b32 s34, s34, 7
    s_add_u32 m0, s45, 0
    s_nop 0
    buffer_load_dwordx4 v17, s[4:7], s42 offen lds
    s_and_b32 s28, s25, 1
    s_lshl_b32 s28, s28, 1
    s_lshl_b32 s29, s27, 2
    s_add_u32 s28, s28, s29
    s_add_u32 m0, s45, 1024
    s_nop 0
    buffer_load_dwordx4 v18, s[4:7], s42 offen lds
    s_lshr_b32 s29, s25, 1
    s_lshl_b32 s30, s26, 1
    s_add_u32 s29, s29, s30
    s_lshl_b32 s30, s28, 16
    s_add_u32 m0, s45, 2048
    s_nop 0
    buffer_load_dwordx4 v19, s[4:7], s42 offen lds
    s_lshl_b32 s31, s29, 10
    s_add_u32 s30, s30, s31
    v_lshrrev_b32 v32, 4, v1
    v_and_b32 v32, 1, v32
    s_add_u32 m0, s45, 3072
    s_nop 0
    buffer_load_dwordx4 v20, s[4:7], s42 offen lds
    v_lshlrev_b32 v32, 16, v32
    v_lshrrev_b32 v33, 5, v1
    v_lshlrev_b32 v33, 8, v33
    v_add_u32 v32, v32, v33
    s_add_u32 m0, s46, 0
    s_nop 0
    buffer_load_dwordx4 v21, s[12:15], s43 offen lds
    v_and_b32 v33, 15, v1
    v_lshlrev_b32 v33, 4, v33
    v_add_u32 v48, v32, v33
    s_mov_b32 s52, 0x3eb8aa3b
    s_add_u32 m0, s46, 1024
    s_nop 0
    buffer_load_dwordx4 v22, s[12:15], s43 offen lds
    v_accvgpr_read_b32 v32, a16
    v_accvgpr_read_b32 v33, a17
    v_cvt_pk_bf16_f32 v36, v32, v33
    v_accvgpr_read_b32 v34, a18
    s_add_u32 m0, s46, 2048
    s_nop 0
    buffer_load_dwordx4 v23, s[12:15], s43 offen lds
    v_accvgpr_read_b32 v35, a19
    v_cvt_pk_bf16_f32 v37, v34, v35
    v_accvgpr_read_b32 v32, a20
    v_accvgpr_read_b32 v33, a21
    s_add_u32 m0, s46, 12288
    s_nop 0
    buffer_load_dwordx4 v21, s[16:19], s43 offen lds
    v_cvt_pk_bf16_f32 v38, v32, v33
    v_accvgpr_read_b32 v34, a22
    v_accvgpr_read_b32 v35, a23
    v_cvt_pk_bf16_f32 v39, v34, v35
    s_add_u32 m0, s46, 13312
    s_nop 0
    buffer_load_dwordx4 v22, s[16:19], s43 offen lds
    s_add_u32 s31, s30, 0x200000
    buffer_store_dwordx4 v[36:39], v2, s[20:23], s31 offen sc1
    v_dot2_f32_bf16 v46, v36, v36, 0
    v_dot2_f32_bf16 v46, v37, v37, v46
    s_add_u32 m0, s46, 14336
    s_nop 0
    buffer_load_dwordx4 v23, s[16:19], s43 offen lds
    v_dot2_f32_bf16 v46, v38, v38, v46
    v_dot2_f32_bf16 v46, v39, v39, v46
    v_accvgpr_read_b32 v32, a24
    v_accvgpr_read_b32 v33, a25
    v_cvt_pk_bf16_f32 v40, v32, v33
    s_add_u32 s40, s40, 40960
    s_cmp_eq_u32 s40, 163840
    s_cselect_b32 s40, 0, s40
    s_barrier
    s_lshl_b32 s42, s34, 7
    s_add_u32 s42, s42, s35
    s_mul_i32 s43, s34, 176128
    s_add_u32 s43, s43, s36
    s_add_u32 s45, s40, s37
    s_add_u32 s46, s40, s38
    s_add_u32 s34, s34, 1
    s_and_b32 s34, s34, 7
    s_add_u32 m0, s45, 0
    s_nop 0
    buffer_load_dwordx4 v17, s[4:7], s42 offen lds
    v_accvgpr_read_b32 v34, a26
    v_accvgpr_read_b32 v35, a27
    v_cvt_pk_bf16_f32 v41, v34, v35
    v_accvgpr_read_b32 v32, a28
    v_accvgpr_read_b32 v33, a29
    v_cvt_pk_bf16_f32 v42, v32, v33
    v_accvgpr_read_b32 v34, a30
    v_accvgpr_read_b32 v35, a31
    v_cvt_pk_bf16_f32 v43, v34, v35
    s_add_u32 m0, s45, 1024
    s_nop 0
    buffer_load_dwordx4 v18, s[4:7], s42 offen lds
    s_add_u32 s31, s30, 0x210000
    buffer_store_dwordx4 v[40:43], v2, s[20:23], s31 offen sc1
    v_dot2_f32_bf16 v47, v40, v40, 0
    v_dot2_f32_bf16 v47, v41, v41, v47
    v_dot2_f32_bf16 v47, v42, v42, v47
    v_dot2_f32_bf16 v47, v43, v43, v47
    v_accvgpr_read_b32 v32, a32
    v_accvgpr_read_b32 v33, a33
    v_cvt_pk_bf16_f32 v36, v32, v33
    v_accvgpr_read_b32 v34, a34
    s_add_u32 m0, s45, 2048
    s_nop 0
    buffer_load_dwordx4 v19, s[4:7], s42 offen lds
    v_accvgpr_read_b32 v35, a35
    v_cvt_pk_bf16_f32 v37, v34, v35
    v_accvgpr_read_b32 v32, a36
    v_accvgpr_read_b32 v33, a37
    v_cvt_pk_bf16_f32 v38, v32, v33
    v_accvgpr_read_b32 v34, a38
    v_accvgpr_read_b32 v35, a39
    v_cvt_pk_bf16_f32 v39, v34, v35
    s_add_u32 s31, s30, 0x400000
    s_add_u32 m0, s45, 3072
    s_nop 0
    buffer_load_dwordx4 v20, s[4:7], s42 offen lds
    buffer_store_dwordx4 v[36:39], v48, s[20:23], s31 offen sc1
    v_accvgpr_read_b32 v32, a40
    v_accvgpr_read_b32 v33, a41
    v_cvt_pk_bf16_f32 v40, v32, v33
    v_accvgpr_read_b32 v34, a42
    v_accvgpr_read_b32 v35, a43
    v_cvt_pk_bf16_f32 v41, v34, v35
    v_accvgpr_read_b32 v32, a44
    v_accvgpr_read_b32 v33, a45
    v_cvt_pk_bf16_f32 v42, v32, v33
    s_add_u32 m0, s46, 0
    s_nop 0
    buffer_load_dwordx4 v21, s[12:15], s43 offen lds
    v_accvgpr_read_b32 v34, a46
    v_accvgpr_read_b32 v35, a47
    v_cvt_pk_bf16_f32 v43, v34, v35
    s_add_u32 s31, s30, 0x400000
    buffer_store_dwordx4 v[40:43], v48, s[20:23], s31 offen offset:512 sc1
    v_accvgpr_read_b32 v32, a0
    v_accvgpr_read_b32 v33, a1
    v_mul_f32 v32, s52, v32
    v_mul_f32 v33, s52, v33
    v_cvt_pk_bf16_f32 v36, v32, v33
    s_add_u32 m0, s46, 1024
    s_nop 0
    buffer_load_dwordx4 v22, s[12:15], s43 offen lds
    v_accvgpr_read_b32 v34, a2
    v_accvgpr_read_b32 v35, a3
    v_mul_f32 v34, s52, v34
    v_mul_f32 v35, s52, v35
    v_cvt_pk_bf16_f32 v37, v34, v35
    v_accvgpr_read_b32 v32, a4
    v_accvgpr_read_b32 v33, a5
    v_mul_f32 v32, s52, v32
    v_mul_f32 v33, s52, v33
    s_add_u32 m0, s46, 2048
    s_nop 0
    buffer_load_dwordx4 v23, s[12:15], s43 offen lds
    v_cvt_pk_bf16_f32 v38, v32, v33
    v_accvgpr_read_b32 v34, a6
    v_accvgpr_read_b32 v35, a7
    v_mul_f32 v34, s52, v34
    v_mul_f32 v35, s52, v35
    v_cvt_pk_bf16_f32 v39, v34, v35
    s_add_u32 s31, s30, 0x0
    buffer_store_dwordx4 v[36:39], v2, s[20:23], s31 offen sc1
    v_dot2_f32_bf16 v44, v36, v36, 0
    v_dot2_f32_bf16 v44, v37, v37, v44
    s_add_u32 m0, s46, 12288
    s_nop 0
    buffer_load_dwordx4 v21, s[16:19], s43 offen lds
    v_dot2_f32_bf16 v44, v38, v38, v44
    v_dot2_f32_bf16 v44, v39, v39, v44
    v_accvgpr_read_b32 v32, a8
    v_accvgpr_read_b32 v33, a9
    v_mul_f32 v32, s52, v32
    v_mul_f32 v33, s52, v33
    v_cvt_pk_bf16_f32 v40, v32, v33
    v_accvgpr_read_b32 v34, a10
    v_accvgpr_read_b32 v35, a11
    s_add_u32 m0, s46, 13312
    s_nop 0
    buffer_load_dwordx4 v22, s[16:19], s43 offen lds
    v_mul_f32 v34, s52, v34
    v_mul_f32 v35, s52, v35
    v_cvt_pk_bf16_f32 v41, v34, v35
    v_accvgpr_read_b32 v32, a12
    v_accvgpr_read_b32 v33, a13
    v_mul_f32 v32, s52, v32
    v_mul_f32 v33, s52, v33
    v_cvt_pk_bf16_f32 v42, v32, v33
    v_accvgpr_read_b32 v34, a14
    v_accvgpr_read_b32 v35, a15
    s_add_u32 m0, s46, 14336
    s_nop 0
    buffer_load_dwordx4 v23, s[16:19], s43 offen lds
    v_mul_f32 v34, s52, v34
    v_mul_f32 v35, s52, v35
    v_cvt_pk_bf16_f32 v43, v34, v35
    s_add_u32 s31, s30, 0x10000
    buffer_store_dwordx4 v[40:43], v2, s[20:23], s31 offen sc1
    v_dot2_f32_bf16 v45, v40, v40, 0
    v_dot2_f32_bf16 v45, v41, v41, v45
    v_dot2_f32_bf16 v45, v42, v42, v45
    v_dot2_f32_bf16 v45, v43, v43, v45
    s_nop 2
    s_add_u32 s40, s40, 40960
    s_cmp_eq_u32 s40, 163840
    s_cselect_b32 s40, 0, s40
    s_nop 0
    v_mov_b32 v32, v44
    v_mov_b32 v33, v45
    v_mov_b32 v34, v46
    v_mov_b32 v35, v47
    v_permlane32_swap_b32 v44, v32
    v_permlane32_swap_b32 v45, v33
    v_permlane32_swap_b32 v46, v34
    v_permlane32_swap_b32 v47, v35
    s_nop 0
    v_add_f32 v44, v44, v32
    v_add_f32 v45, v45, v33
    v_add_f32 v46, v46, v34
    v_add_f32 v47, v47, v35
    v_mov_b32 v32, v44
    v_mov_b32 v33, v45
    v_mov_b32 v34, v46
    v_mov_b32 v35, v47
    v_permlane16_swap_b32 v44, v32
    v_permlane16_swap_b32 v45, v33
    v_permlane16_swap_b32 v46, v34
    v_permlane16_swap_b32 v47, v35
    s_nop 0
    v_max_f32 v44, v44, v32
    v_max_f32 v45, v45, v33
    v_max_f32 v46, v46, v34
    v_max_f32 v47, v47, v35
    v_max_f32_dpp v44, v44, v44 row_ror:8 row_mask:0xf bank_mask:0xf
    v_max_f32_dpp v45, v45, v45 row_ror:8 row_mask:0xf bank_mask:0xf
    v_max_f32_dpp v46, v46, v46 row_ror:8 row_mask:0xf bank_mask:0xf
    v_max_f32_dpp v47, v47, v47 row_ror:8 row_mask:0xf bank_mask:0xf
    v_max_f32_dpp v44, v44, v44 row_ror:4 row_mask:0xf bank_mask:0xf
    v_max_f32_dpp v45, v45, v45 row_ror:4 row_mask:0xf bank_mask:0xf
    v_max_f32_dpp v46, v46, v46 row_ror:4 row_mask:0xf bank_mask:0xf
    v_max_f32_dpp v47, v47, v47 row_ror:4 row_mask:0xf bank_mask:0xf
    v_max_f32_dpp v44, v44, v44 row_ror:2 row_mask:0xf bank_mask:0xf
    v_max_f32_dpp v45, v45, v45 row_ror:2 row_mask:0xf bank_mask:0xf
    v_max_f32_dpp v46, v46, v46 row_ror:2 row_mask:0xf bank_mask:0xf
    v_max_f32_dpp v47, v47, v47 row_ror:2 row_mask:0xf bank_mask:0xf
    v_max_f32_dpp v44, v44, v44 row_ror:1 row_mask:0xf bank_mask:0xf
    v_max_f32_dpp v45, v45, v45 row_ror:1 row_mask:0xf bank_mask:0xf
    v_max_f32_dpp v46, v46, v46 row_ror:1 row_mask:0xf bank_mask:0xf
    v_max_f32_dpp v47, v47, v47 row_ror:1 row_mask:0xf bank_mask:0xf
    s_lshl_b32 s30, s28, 8
    s_lshl_b32 s31, s29, 2
    s_add_u32 s30, s30, s31
    s_add_u32 s30, s30, 0xe00000
    v_mov_b32 v32, 0
    s_add_u32 s31, s30, 0x2000
    s_mov_b64 exec, 1
    buffer_store_dword v44, v32, s[20:23], s30 offen sc1
    buffer_store_dword v45, v32, s[20:23], s30 offen offset:256 sc1
    buffer_store_dword v46, v32, s[20:23], s31 offen sc1
    buffer_store_dword v47, v32, s[20:23], s31 offen offset:256 sc1
    s_mov_b64 exec, -1
    s_waitcnt vmcnt(19)
    s_barrier
    s_lshl_b32 s42, s34, 7
    s_add_u32 s42, s42, s35
    s_mul_i32 s43, s34, 176128
    s_add_u32 s43, s43, s36
    s_add_u32 s45, s40, s37
    s_add_u32 s46, s40, s38
    s_add_u32 s34, s34, 1
    s_and_b32 s34, s34, 7
    s_add_u32 m0, s45, 0
    s_nop 0
    buffer_load_dwordx4 v17, s[4:7], s42 offen lds
    s_add_u32 m0, s45, 1024
    s_nop 0
    buffer_load_dwordx4 v18, s[4:7], s42 offen lds
    s_add_u32 m0, s45, 2048
    s_nop 0
    buffer_load_dwordx4 v19, s[4:7], s42 offen lds
    s_add_u32 m0, s45, 3072
    s_nop 0
    buffer_load_dwordx4 v20, s[4:7], s42 offen lds
    s_add_u32 m0, s46, 0
    s_nop 0
    buffer_load_dwordx4 v21, s[12:15], s43 offen lds
    s_add_u32 m0, s46, 1024
    s_nop 0
    buffer_load_dwordx4 v22, s[12:15], s43 offen lds
    s_add_u32 m0, s46, 2048
    s_nop 0
    buffer_load_dwordx4 v23, s[12:15], s43 offen lds
    s_add_u32 m0, s46, 12288
    s_nop 0
    buffer_load_dwordx4 v21, s[16:19], s43 offen lds
    s_add_u32 m0, s46, 13312
    s_nop 0
    buffer_load_dwordx4 v22, s[16:19], s43 offen lds
    s_add_u32 m0, s46, 14336
    s_nop 0
    buffer_load_dwordx4 v23, s[16:19], s43 offen lds
    s_add_u32 s40, s40, 40960
    s_cmp_eq_u32 s40, 163840
    s_cselect_b32 s40, 0, s40
    s_waitcnt vmcnt(10)
    v_readfirstlane_b32 s56, v29
    s_nop 3
    s_cmp_lg_u32 s56, 0
    s_cbranch_scc1 NONCE_OKa1
    s_mov_b32 s61, 0
    v_mov_b32 v4, 0
NONCE_La1:
    global_load_dword v3, v4, s[82:83] sc1
    s_waitcnt vmcnt(0)
    v_readfirstlane_b32 s56, v3
    s_add_u32 s61, s61, 1
    s_cmp_gt_u32 s61, 400000
    s_cbranch_scc1 NONCE_Da1
    s_cmp_eq_u32 s56, 0
    s_cbranch_scc1 NONCE_La1
NONCE_Da1:
NONCE_OKa1:
    s_lshl_b32 s48, s27, 5
    s_add_u32 s48, s48, s26
    s_lshl_b32 s48, s48, 2
    s_add_u32 s48, s48, s25
    s_lshl_b32 s48, s48, 2
    s_add_u32 s48, s48, 0xe10000
    v_mov_b32 v3, s56
    v_mov_b32 v4, 0
    s_mov_b64 exec, 1
    buffer_store_dword v3, v4, s[20:23], s48 offen sc1
    s_mov_b64 exec, -1
    s_barrier
    s_lshl_b32 s42, s34, 7
    s_add_u32 s42, s42, s35
    s_mul_i32 s43, s34, 176128
    s_add_u32 s43, s43, s36
    s_add_u32 s45, s40, s37
    s_add_u32 s46, s40, s38
    s_add_u32 s34, s34, 1
    s_and_b32 s34, s34, 7
    s_add_u32 m0, s45, 0
    s_nop 0
    buffer_load_dwordx4 v17, s[4:7], s42 offen lds
    s_add_u32 m0, s45, 1024
    s_nop 0
    buffer_load_dwordx4 v18, s[4:7], s42 offen lds
    s_add_u32 m0, s45, 2048
    s_nop 0
    buffer_load_dwordx4 v19, s[4:7], s42 offen lds
    s_add_u32 m0, s45, 3072
    s_nop 0
    buffer_load_dwordx4 v20, s[4:7], s42 offen lds
    s_add_u32 m0, s46, 0
    s_nop 0
    buffer_load_dwordx4 v21, s[12:15], s43 offen lds
    s_add_u32 m0, s46, 1024
    s_nop 0
    buffer_load_dwordx4 v22, s[12:15], s43 offen lds
    s_add_u32 m0, s46, 2048
    s_nop 0
    buffer_load_dwordx4 v23, s[12:15], s43 offen lds
    s_add_u32 m0, s46, 12288
    s_nop 0
    buffer_load_dwordx4 v21, s[16:19], s43 offen lds
    s_add_u32 m0, s46, 13312
    s_nop 0
    buffer_load_dwordx4 v22, s[16:19], s43 offen lds
    s_add_u32 m0, s46, 14336
    s_nop 0
    buffer_load_dwordx4 v23, s[16:19], s43 offen lds
    s_add_u32 s40, s40, 40960
    s_cmp_eq_u32 s40, 163840
    s_cselect_b32 s40, 0, s40
    s_waitcnt vmcnt(10)
    s_barrier
    s_lshl_b32 s42, s34, 7
    s_add_u32 s42, s42, s35
    s_mul_i32 s43, s34, 176128
    s_add_u32 s43, s43, s36
    s_add_u32 s45, s40, s37
    s_add_u32 s46, s40, s38
    s_add_u32 s34, s34, 1
    s_and_b32 s34, s34, 7
    s_add_u32 m0, s45, 0
    s_nop 0
    buffer_load_dwordx4 v17, s[4:7], s42 offen lds
    s_add_u32 m0, s45, 1024
    s_nop 0
    buffer_load_dwordx4 v18, s[4:7], s42 offen lds
    s_add_u32 m0, s45, 2048
    s_nop 0
    buffer_load_dwordx4 v19, s[4:7], s42 offen lds
    s_add_u32 m0, s45, 3072
    s_nop 0
    buffer_load_dwordx4 v20, s[4:7], s42 offen lds
    s_add_u32 m0, s46, 0
    s_nop 0
    buffer_load_dwordx4 v21, s[12:15], s43 offen lds
    s_add_u32 m0, s46, 1024
    s_nop 0
    buffer_load_dwordx4 v22, s[12:15], s43 offen lds
    s_add_u32 m0, s46, 2048
    s_nop 0
    buffer_load_dwordx4 v23, s[12:15], s43 offen lds
    s_add_u32 m0, s46, 12288
    s_nop 0
    buffer_load_dwordx4 v21, s[16:19], s43 offen lds
    s_add_u32 m0, s46, 13312
    s_nop 0
    buffer_load_dwordx4 v22, s[16:19], s43 offen lds
    s_add_u32 m0, s46, 14336
    s_nop 0
    buffer_load_dwordx4 v23, s[16:19], s43 offen lds
    s_add_u32 s40, s40, 40960
    s_cmp_eq_u32 s40, 163840
    s_cselect_b32 s40, 0, s40
    s_waitcnt vmcnt(10)
    s_barrier
    s_mov_b32 s61, 0
    s_lshr_b32 s48, s57, 2
    s_lshl_b32 s48, s48, 9
    s_add_u32 s48, s48, 0xe10000
    v_lshlrev_b32 v5, 3, v1
    buffer_load_dwordx2 v[14:15], v5, s[20:23], s48 offen sc1
    s_lshl_b32 s42, s34, 7
    s_add_u32 s42, s42, s35
    s_mul_i32 s43, s34, 176128
    s_add_u32 s43, s43, s36
    s_add_u32 s45, s40, s37
    s_add_u32 s46, s40, s38
    s_add_u32 s34, s34, 1
    s_and_b32 s34, s34, 7
    s_add_u32 m0, s45, 0
    s_nop 0
    buffer_load_dwordx4 v17, s[4:7], s42 offen lds
    s_add_u32 m0, s45, 1024
    s_nop 0
    buffer_load_dwordx4 v18, s[4:7], s42 offen lds
    s_add_u32 m0, s45, 2048
    s_nop 0
    buffer_load_dwordx4 v19, s[4:7], s42 offen lds
    s_add_u32 m0, s45, 3072
    s_nop 0
    buffer_load_dwordx4 v20, s[4:7], s42 offen lds
    s_add_u32 m0, s46, 0
    s_nop 0
    buffer_load_dwordx4 v21, s[12:15], s43 offen lds
    s_add_u32 m0, s46, 1024
    s_nop 0
    buffer_load_dwordx4 v22, s[12:15], s43 offen lds
    s_add_u32 m0, s46, 2048
    s_nop 0
    buffer_load_dwordx4 v23, s[12:15], s43 offen lds
    s_add_u32 m0, s46, 12288
    s_nop 0
    buffer_load_dwordx4 v21, s[16:19], s43 offen lds
    s_add_u32 m0, s46, 13312
    s_nop 0
    buffer_load_dwordx4 v22, s[16:19], s43 offen lds
    s_add_u32 m0, s46, 14336
    s_nop 0
    buffer_load_dwordx4 v23, s[16:19], s43 offen lds
    s_add_u32 s40, s40, 40960
    s_cmp_eq_u32 s40, 163840
    s_cselect_b32 s40, 0, s40
    s_waitcnt vmcnt(10)
    s_barrier
S1_CKl:
    v_cmp_ne_u32 vcc, s56, v14
    v_cmp_ne_u32 s[50:51], s56, v15
    s_nop 3
    s_or_b64 vcc, vcc, s[50:51]
    s_cmp_eq_u64 vcc, 0
    s_cbranch_scc1 S1_OKl
    s_add_u32 s61, s61, 1
    s_cmp_gt_u32 s61, 400000
    s_cbranch_scc1 S1_OKl
    s_sleep 8
    s_lshr_b32 s48, s57, 2
    s_lshl_b32 s48, s48, 9
    s_add_u32 s48, s48, 0xe10000
    v_lshlrev_b32 v5, 3, v1
    buffer_load_dwordx2 v[14:15], v5, s[20:23], s48 offen sc1
    s_waitcnt vmcnt(0)
    s_branch S1_CKl
S1_OKl:
    s_lshl_b32 s48, s57, 16
    s_lshl_b32 s49, s58, 13
    s_add_u32 s59, s48, s49
    s_lshr_b32 s49, s24, 2
    s_lshl_b32 s49, s49, 12
    s_add_u32 s59, s59, s49
    s_add_u32 s59, s59, 0x0
    s_lshl_b32 s49, s25, 14
    s_add_u32 s49, s49, s48
    s_add_u32 s42, s49, 0x200000
    s_add_u32 s43, s49, 0x400000
    v_mov_b32 v76, 0
    v_mov_b32 v77, 0
    v_mov_b32 v78, 0
    v_mov_b32 v79, 0
    v_and_b32 v4, 31, v1
    v_cmp_eq_u32 vcc, 16, v4
    v_mov_b32 v4, 0x3f803f80
    s_nop 1
    v_cndmask_b32 v3, 0, v4, vcc
    s_nop 0
    v_accvgpr_write_b32 a0, v3
    v_accvgpr_write_b32 a1, v3
    v_accvgpr_write_b32 a2, v3
    v_accvgpr_write_b32 a3, v3
    v_accvgpr_write_b32 a4, v3
    v_accvgpr_write_b32 a5, v3
    v_accvgpr_write_b32 a6, v3
    v_accvgpr_write_b32 a7, v3
    v_accvgpr_write_b32 a8, v3
    v_accvgpr_write_b32 a9, v3
    v_accvgpr_write_b32 a10, v3
    v_accvgpr_write_b32 a11, v3
    v_accvgpr_write_b32 a12, v3
    v_accvgpr_write_b32 a13, v3
    v_accvgpr_write_b32 a14, v3
    v_accvgpr_write_b32 a15, v3
    s_nop 1
    v_mfma_f32_32x32x16_bf16 a[16:31], v[76:79], v[76:79], a[0:15]
    v_mfma_f32_32x32x16_bf16 a[32:47], v[76:79], v[76:79], a[0:15]
    v_mfma_f32_32x32x16_bf16 a[48:63], v[76:79], v[76:79], a[0:15]
    v_lshrrev_b32 v3, 5, v1
    v_lshlrev_b32 v3, 8, v3
    v_and_b32 v4, 15, v1
    v_lshlrev_b32 v4, 4, v4
    v_add_u32 v12, v3, v4
    s_mov_b32 s62, 0x0000ffff
    s_mov_b32 s63, 0x0000ffff
    s_nop 7
    v_lshlrev_b32 v3, 2, v1
    s_lshl_b32 s48, s57, 8
    s_add_u32 s49, s48, 0xe02000
    buffer_load_dword v14, v3, s[20:23], s49 offen sc1
    v_and_b32 v4, 7, v1
    v_lshlrev_b32 v4, 2, v4
    s_lshl_b32 s50, s58, 5
    s_add_u32 s49, s48, s50
    s_add_u32 s49, s49, 0xe00000
    buffer_load_dword v15, v4, s[20:23], s49 offen sc1
    buffer_load_dwordx4 v[72:75], v2, s[20:23], s59 offen sc1
    buffer_load_dwordx4 v[80:83], v2, s[20:23], s42 offen offset:0 sc1
    s_mov_b64 exec, s[62:63]
    buffer_load_dwordx4 a[0:3], v12, s[20:23], s43 offen offset:0 sc1
    buffer_load_dwordx4 a[4:7], v12, s[20:23], s43 offen offset:512 sc1
    s_mov_b64 exec, -1
    buffer_load_dwordx4 v[84:87], v2, s[20:23], s42 offen offset:1024 sc1
    s_mov_b64 exec, s[62:63]
    buffer_load_dwordx4 a[8:11], v12, s[20:23], s43 offen offset:1024 sc1
    buffer_load_dwordx4 a[12:15], v12, s[20:23], s43 offen offset:1536 sc1
    s_mov_b64 exec, -1
    buffer_load_dwordx4 v[88:91], v2, s[20:23], s42 offen offset:2048 sc1
    s_mov_b64 exec, s[62:63]
    buffer_load_dwordx4 a[16:19], v12, s[20:23], s43 offen offset:2048 sc1
    buffer_load_dwordx4 a[20:23], v12, s[20:23], s43 offen offset:2560 sc1
    s_mov_b64 exec, -1
    s_waitcnt vmcnt(12)
    s_barrier
    buffer_load_dwordx4 v[92:95], v2, s[20:23], s42 offen offset:3072 sc1
    s_add_u32 s42, s42, 4096
    s_mov_b64 exec, s[62:63]
    buffer_load_dwordx4 a[24:27], v12, s[20:23], s43 offen offset:3072 sc1
    buffer_load_dwordx4 a[28:31], v12, s[20:23], s43 offen offset:3584 sc1
    s_mov_b64 exec, -1
    s_add_u32 s43, s43, 4096
    buffer_load_dwordx4 v[96:99], v2, s[20:23], s42 offen offset:0 sc1
    s_mov_b64 exec, s[62:63]
    buffer_load_dwordx4 a[32:35], v12, s[20:23], s43 offen offset:0 sc1
    buffer_load_dwordx4 a[36:39], v12, s[20:23], s43 offen offset:512 sc1
    s_mov_b64 exec, -1
    buffer_load_dwordx4 v[100:103], v2, s[20:23], s42 offen offset:1024 sc1
    s_mov_b64 exec, s[62:63]
    buffer_load_dwordx4 a[40:43], v12, s[20:23], s43 offen offset:1024 sc1
    buffer_load_dwordx4 a[44:47], v12, s[20:23], s43 offen offset:1536 sc1
    s_mov_b64 exec, -1
    buffer_load_dwordx4 v[104:107], v2, s[20:23], s42 offen offset:2048 sc1
    s_mov_b64 exec, s[62:63]
    buffer_load_dwordx4 a[48:51], v12, s[20:23], s43 offen offset:2048 sc1
    buffer_load_dwordx4 a[52:55], v12, s[20:23], s43 offen offset:2560 sc1
    s_mov_b64 exec, -1
    buffer_load_dwordx4 v[108:111], v2, s[20:23], s42 offen offset:3072 sc1
    s_mov_b64 exec, s[62:63]
    buffer_load_dwordx4 a[56:59], v12, s[20:23], s43 offen offset:3072 sc1
    buffer_load_dwordx4 a[60:63], v12, s[20:23], s43 offen offset:3584 sc1
    s_mov_b64 exec, -1
    s_add_u32 s8, s84, 0x800000
    s_addc_u32 s9, s85, 0
    s_mov_b32 s10, 0x560000
    s_mov_b32 s11, 0x00020000
    s_mov_b32 s12, s76
    s_mov_b32 s13, s77
    s_mov_b32 s14, 0x158000
    s_mov_b32 s15, 0x00020000
    s_mov_b32 s16, s80
    s_mov_b32 s17, s81
    s_mov_b32 s18, 0x200000
    s_mov_b32 s19, 0x00020000
    s_barrier
    s_waitcnt vmcnt(0)
    v_mov_b32 v3, v14
    v_mov_b32 v4, v15
    s_nop 0
    v_permlane32_swap_b32 v14, v3
    v_permlane32_swap_b32 v15, v4
    s_nop 0
    v_max_f32 v14, v14, v3
    v_max_f32 v15, v15, v4
    v_mov_b32 v3, v14
    v_mov_b32 v4, v15
    s_nop 0
    v_permlane16_swap_b32 v14, v3
    v_permlane16_swap_b32 v15, v4
    s_nop 0
    v_max_f32 v14, v14, v3
    v_max_f32 v15, v15, v4
    s_nop 0
    v_max_f32_dpp v14, v14, v14 row_ror:8 row_mask:0xf bank_mask:0xf
    v_max_f32_dpp v15, v15, v15 row_ror:8 row_mask:0xf bank_mask:0xf
    s_nop 0
    v_max_f32_dpp v14, v14, v14 row_ror:4 row_mask:0xf bank_mask:0xf
    v_max_f32_dpp v15, v15, v15 row_ror:4 row_mask:0xf bank_mask:0xf
    s_nop 0
    v_max_f32_dpp v14, v14, v14 row_ror:2 row_mask:0xf bank_mask:0xf
    v_max_f32_dpp v15, v15, v15 row_ror:2 row_mask:0xf bank_mask:0xf
    s_nop 0
    v_max_f32_dpp v14, v14, v14 row_ror:1 row_mask:0xf bank_mask:0xf
    v_max_f32_dpp v15, v15, v15 row_ror:1 row_mask:0xf bank_mask:0xf
    v_mul_f32 v14, v14, v15
    v_sqrt_f32 v14, v14
    v_mov_b32 v15, 0x42400000
    v_cmp_nle_f32 vcc, v14, v15
    v_sub_f32 v14, 0, v14
    s_nop 1
    s_cmp_lg_u64 vcc, 0
    s_cselect_b32 s60, 1, 0
    v_mov_b32 v48, v14
    v_mov_b32 v49, v14
    v_mov_b32 v50, v14
    v_mov_b32 v51, v14
    v_mov_b32 v52, v14
    v_mov_b32 v53, v14
    v_mov_b32 v54, v14
    v_mov_b32 v55, v14
    v_mov_b32 v56, v14
    v_mov_b32 v57, v14
    v_mov_b32 v58, v14
    v_mov_b32 v59, v14
    v_mov_b32 v60, v14
    v_mov_b32 v61, v14
    v_mov_b32 v62, v14
    v_mov_b32 v63, v14
    s_barrier
    s_branch A_DONE
A_GATE:
    s_nop 7
    s_and_b32 s28, s25, 1
    s_lshl_b32 s28, s28, 1
    s_lshl_b32 s29, s27, 2
    s_add_u32 s28, s28, s29
    s_lshr_b32 s29, s25, 1
    s_lshl_b32 s30, s26, 1
    s_add_u32 s29, s29, s30
    s_lshl_b32 s30, s28, 16
    s_lshl_b32 s31, s29, 10
    s_add_u32 s30, s30, s31
    v_lshrrev_b32 v32, 4, v1
    v_and_b32 v32, 1, v32
    v_lshlrev_b32 v32, 16, v32
    v_lshrrev_b32 v33, 5, v1
    v_lshlrev_b32 v33, 8, v33
    v_add_u32 v32, v32, v33
    v_and_b32 v33, 15, v1
    v_lshlrev_b32 v33, 4, v33
    v_add_u32 v48, v32, v33
    s_mov_b32 s52, 0x3eb8aa3b
    v_accvgpr_read_b32 v32, a16
    v_accvgpr_read_b32 v33, a17
    v_cvt_pk_bf16_f32 v36, v32, v33
    v_accvgpr_read_b32 v34, a18
    v_accvgpr_read_b32 v35, a19
    v_cvt_pk_bf16_f32 v37, v34, v35
    v_accvgpr_read_b32 v32, a20
    v_accvgpr_read_b32 v33, a21
    v_cvt_pk_bf16_f32 v38, v32, v33
    v_accvgpr_read_b32 v34, a22
    v_accvgpr_read_b32 v35, a23
    v_cvt_pk_bf16_f32 v39, v34, v35
    s_add_u32 s31, s30, 0x200000
    buffer_store_dwordx4 v[36:39], v2, s[20:23], s31 offen sc1
    v_dot2_f32_bf16 v46, v36, v36, 0
    v_dot2_f32_bf16 v46, v37, v37, v46
    v_dot2_f32_bf16 v46, v38, v38, v46
    v_dot2_f32_bf16 v46, v39, v39, v46
    v_accvgpr_read_b32 v32, a24
    v_accvgpr_read_b32 v33, a25
    v_cvt_pk_bf16_f32 v40, v32, v33
    v_accvgpr_read_b32 v34, a26
    v_accvgpr_read_b32 v35, a27
    v_cvt_pk_bf16_f32 v41, v34, v35
    v_accvgpr_read_b32 v32, a28
    v_accvgpr_read_b32 v33, a29
    v_cvt_pk_bf16_f32 v42, v32, v33
    v_accvgpr_read_b32 v34, a30
    v_accvgpr_read_b32 v35, a31
    v_cvt_pk_bf16_f32 v43, v34, v35
    s_add_u32 s31, s30, 0x210000
    buffer_store_dwordx4 v[40:43], v2, s[20:23], s31 offen sc1
    v_dot2_f32_bf16 v47, v40, v40, 0
    v_dot2_f32_bf16 v47, v41, v41, v47
    v_dot2_f32_bf16 v47, v42, v42, v47
    v_dot2_f32_bf16 v47, v43, v43, v47
    v_accvgpr_read_b32 v32, a32
    v_accvgpr_read_b32 v33, a33
    v_cvt_pk_bf16_f32 v36, v32, v33
    v_accvgpr_read_b32 v34, a34
    v_accvgpr_read_b32 v35, a35
    v_cvt_pk_bf16_f32 v37, v34, v35
    v_accvgpr_read_b32 v32, a36
    v_accvgpr_read_b32 v33, a37
    v_cvt_pk_bf16_f32 v38, v32, v33
    v_accvgpr_read_b32 v34, a38
    v_accvgpr_read_b32 v35, a39
    v_cvt_pk_bf16_f32 v39, v34, v35
    s_add_u32 s31, s30, 0x400000
    buffer_store_dwordx4 v[36:39], v48, s[20:23], s31 offen sc1
    v_accvgpr_read_b32 v32, a40
    v_accvgpr_read_b32 v33, a41
    v_cvt_pk_bf16_f32 v40, v32, v33
    v_accvgpr_read_b32 v34, a42
    v_accvgpr_read_b32 v35, a43
    v_cvt_pk_bf16_f32 v41, v34, v35
    v_accvgpr_read_b32 v32, a44
    v_accvgpr_read_b32 v33, a45
    v_cvt_pk_bf16_f32 v42, v32, v33
    v_accvgpr_read_b32 v34, a46
    v_accvgpr_read_b32 v35, a47
    v_cvt_pk_bf16_f32 v43, v34, v35
    s_add_u32 s31, s30, 0x400000
    buffer_store_dwordx4 v[40:43], v48, s[20:23], s31 offen offset:512 sc1
    v_accvgpr_read_b32 v32, a0
    v_accvgpr_read_b32 v33, a1
    v_mul_f32 v32, s52, v32
    v_mul_f32 v33, s52, v33
    v_cvt_pk_bf16_f32 v36, v32, v33
    v_accvgpr_read_b32 v34, a2
    v_accvgpr_read_b32 v35, a3
    v_mul_f32 v34, s52, v34
    v_mul_f32 v35, s52, v35
    v_cvt_pk_bf16_f32 v37, v34, v35
    v_accvgpr_read_b32 v32, a4
    v_accvgpr_read_b32 v33, a5
    v_mul_f32 v32, s52, v32
    v_mul_f32 v33, s52, v33
    v_cvt_pk_bf16_f32 v38, v32, v33
    v_accvgpr_read_b32 v34, a6
    v_accvgpr_read_b32 v35, a7
    v_mul_f32 v34, s52, v34
    v_mul_f32 v35, s52, v35
    v_cvt_pk_bf16_f32 v39, v34, v35
    s_add_u32 s31, s30, 0x0
    buffer_store_dwordx4 v[36:39], v2, s[20:23], s31 offen sc1
    v_dot2_f32_bf16 v44, v36, v36, 0
    v_dot2_f32_bf16 v44, v37, v37, v44
    v_dot2_f32_bf16 v44, v38, v38, v44
    v_dot2_f32_bf16 v44, v39, v39, v44
    v_accvgpr_read_b32 v32, a8
    v_accvgpr_read_b32 v33, a9
    v_mul_f32 v32, s52, v32
    v_mul_f32 v33, s52, v33
    v_cvt_pk_bf16_f32 v40, v32, v33
    v_accvgpr_read_b32 v34, a10
    v_accvgpr_read_b32 v35, a11
    v_mul_f32 v34, s52, v34
    v_mul_f32 v35, s52, v35
    v_cvt_pk_bf16_f32 v41, v34, v35
    v_accvgpr_read_b32 v32, a12
    v_accvgpr_read_b32 v33, a13
    v_mul_f32 v32, s52, v32
    v_mul_f32 v33, s52, v33
    v_cvt_pk_bf16_f32 v42, v32, v33
    v_accvgpr_read_b32 v34, a14
    v_accvgpr_read_b32 v35, a15
    v_mul_f32 v34, s52, v34
    v_mul_f32 v35, s52, v35
    v_cvt_pk_bf16_f32 v43, v34, v35
    s_add_u32 s31, s30, 0x10000
    buffer_store_dwordx4 v[40:43], v2, s[20:23], s31 offen sc1
    v_dot2_f32_bf16 v45, v40, v40, 0
    v_dot2_f32_bf16 v45, v41, v41, v45
    v_dot2_f32_bf16 v45, v42, v42, v45
    v_dot2_f32_bf16 v45, v43, v43, v45
    s_nop 2
    s_nop 0
    v_mov_b32 v32, v44
    v_mov_b32 v33, v45
    v_mov_b32 v34, v46
    v_mov_b32 v35, v47
    v_permlane32_swap_b32 v44, v32
    v_permlane32_swap_b32 v45, v33
    v_permlane32_swap_b32 v46, v34
    v_permlane32_swap_b32 v47, v35
    s_nop 0
    v_add_f32 v44, v44, v32
    v_add_f32 v45, v45, v33
    v_add_f32 v46, v46, v34
    v_add_f32 v47, v47, v35
    v_mov_b32 v32, v44
    v_mov_b32 v33, v45
    v_mov_b32 v34, v46
    v_mov_b32 v35, v47
    v_permlane16_swap_b32 v44, v32
    v_permlane16_swap_b32 v45, v33
    v_permlane16_swap_b32 v46, v34
    v_permlane16_swap_b32 v47, v35
    s_nop 0
    v_max_f32 v44, v44, v32
    v_max_f32 v45, v45, v33
    v_max_f32 v46, v46, v34
    v_max_f32 v47, v47, v35
    v_max_f32_dpp v44, v44, v44 row_ror:8 row_mask:0xf bank_mask:0xf
    v_max_f32_dpp v45, v45, v45 row_ror:8 row_mask:0xf bank_mask:0xf
    v_max_f32_dpp v46, v46, v46 row_ror:8 row_mask:0xf bank_mask:0xf
    v_max_f32_dpp v47, v47, v47 row_ror:8 row_mask:0xf bank_mask:0xf
    v_max_f32_dpp v44, v44, v44 row_ror:4 row_mask:0xf bank_mask:0xf
    v_max_f32_dpp v45, v45, v45 row_ror:4 row_mask:0xf bank_mask:0xf
    v_max_f32_dpp v46, v46, v46 row_ror:4 row_mask:0xf bank_mask:0xf
    v_max_f32_dpp v47, v47, v47 row_ror:4 row_mask:0xf bank_mask:0xf
    v_max_f32_dpp v44, v44, v44 row_ror:2 row_mask:0xf bank_mask:0xf
    v_max_f32_dpp v45, v45, v45 row_ror:2 row_mask:0xf bank_mask:0xf
    v_max_f32_dpp v46, v46, v46 row_ror:2 row_mask:0xf bank_mask:0xf
    v_max_f32_dpp v47, v47, v47 row_ror:2 row_mask:0xf bank_mask:0xf
    v_max_f32_dpp v44, v44, v44 row_ror:1 row_mask:0xf bank_mask:0xf
    v_max_f32_dpp v45, v45, v45 row_ror:1 row_mask:0xf bank_mask:0xf
    v_max_f32_dpp v46, v46, v46 row_ror:1 row_mask:0xf bank_mask:0xf
    v_max_f32_dpp v47, v47, v47 row_ror:1 row_mask:0xf bank_mask:0xf
    s_lshl_b32 s30, s28, 8
    s_lshl_b32 s31, s29, 2
    s_add_u32 s30, s30, s31
    s_add_u32 s30, s30, 0xe00000
    v_mov_b32 v32, 0
    s_add_u32 s31, s30, 0x2000
    s_mov_b64 exec, 1
    buffer_store_dword v44, v32, s[20:23], s30 offen sc1
    buffer_store_dword v45, v32, s[20:23], s30 offen offset:256 sc1
    buffer_store_dword v46, v32, s[20:23], s31 offen sc1
    buffer_store_dword v47, v32, s[20:23], s31 offen offset:256 sc1
    s_mov_b64 exec, -1
    s_waitcnt vmcnt(0)
    v_readfirstlane_b32 s56, v29
    s_nop 3
    s_cmp_lg_u32 s56, 0
    s_cbranch_scc1 NONCE_OKa2
    s_mov_b32 s61, 0
    v_mov_b32 v4, 0
NONCE_La2:
    global_load_dword v3, v4, s[82:83] sc1
    s_waitcnt vmcnt(0)
    v_readfirstlane_b32 s56, v3
    s_add_u32 s61, s61, 1
    s_cmp_gt_u32 s61, 400000
    s_cbranch_scc1 NONCE_Da2
    s_cmp_eq_u32 s56, 0
    s_cbranch_scc1 NONCE_La2
NONCE_Da2:
NONCE_OKa2:
    s_lshl_b32 s48, s27, 5
    s_add_u32 s48, s48, s26
    s_lshl_b32 s48, s48, 2
    s_add_u32 s48, s48, s25
    s_lshl_b32 s48, s48, 2
    s_add_u32 s48, s48, 0xe10000
    v_mov_b32 v3, s56
    v_mov_b32 v4, 0
    s_mov_b64 exec, 1
    buffer_store_dword v3, v4, s[20:23], s48 offen sc1
    s_mov_b64 exec, -1
    s_barrier
    s_mov_b32 s61, 0
    s_lshr_b32 s48, s57, 2
    s_lshl_b32 s48, s48, 9
    s_add_u32 s48, s48, 0xe10000
    v_lshlrev_b32 v5, 3, v1
    buffer_load_dwordx2 v[14:15], v5, s[20:23], s48 offen sc1
    s_waitcnt vmcnt(0)
S1_CKlg:
    v_cmp_ne_u32 vcc, s56, v14
    v_cmp_ne_u32 s[50:51], s56, v15
    s_nop 3
    s_or_b64 vcc, vcc, s[50:51]
    s_cmp_eq_u64 vcc, 0
    s_cbranch_scc1 S1_OKlg
    s_add_u32 s61, s61, 1
    s_cmp_gt_u32 s61, 400000
    s_cbranch_scc1 S1_OKlg
    s_sleep 24
    s_lshr_b32 s48, s57, 2
    s_lshl_b32 s48, s48, 9
    s_add_u32 s48, s48, 0xe10000
    v_lshlrev_b32 v5, 3, v1
    buffer_load_dwordx2 v[14:15], v5, s[20:23], s48 offen sc1
    s_waitcnt vmcnt(0)
    s_branch S1_CKlg
S1_OKlg:
    s_lshl_b32 s48, s57, 16
    s_lshl_b32 s49, s58, 13
    s_add_u32 s59, s48, s49
    s_lshr_b32 s49, s24, 2
    s_lshl_b32 s49, s49, 12
    s_add_u32 s59, s59, s49
    s_add_u32 s59, s59, 0x0
    s_lshl_b32 s49, s25, 14
    s_add_u32 s49, s49, s48
    s_add_u32 s42, s49, 0x200000
    s_add_u32 s43, s49, 0x400000
    v_mov_b32 v76, 0
    v_mov_b32 v77, 0
    v_mov_b32 v78, 0
    v_mov_b32 v79, 0
    v_and_b32 v4, 31, v1
    v_cmp_eq_u32 vcc, 16, v4
    v_mov_b32 v4, 0x3f803f80
    s_nop 1
    v_cndmask_b32 v3, 0, v4, vcc
    s_nop 0
    v_accvgpr_write_b32 a0, v3
    v_accvgpr_write_b32 a1, v3
    v_accvgpr_write_b32 a2, v3
    v_accvgpr_write_b32 a3, v3
    v_accvgpr_write_b32 a4, v3
    v_accvgpr_write_b32 a5, v3
    v_accvgpr_write_b32 a6, v3
    v_accvgpr_write_b32 a7, v3
    v_accvgpr_write_b32 a8, v3
    v_accvgpr_write_b32 a9, v3
    v_accvgpr_write_b32 a10, v3
    v_accvgpr_write_b32 a11, v3
    v_accvgpr_write_b32 a12, v3
    v_accvgpr_write_b32 a13, v3
    v_accvgpr_write_b32 a14, v3
    v_accvgpr_write_b32 a15, v3
    s_nop 1
    v_mfma_f32_32x32x16_bf16 a[16:31], v[76:79], v[76:79], a[0:15]
    v_mfma_f32_32x32x16_bf16 a[32:47], v[76:79], v[76:79], a[0:15]
    v_mfma_f32_32x32x16_bf16 a[48:63], v[76:79], v[76:79], a[0:15]
    v_lshrrev_b32 v3, 5, v1
    v_lshlrev_b32 v3, 8, v3
    v_and_b32 v4, 15, v1
    v_lshlrev_b32 v4, 4, v4
    v_add_u32 v12, v3, v4
    s_mov_b32 s62, 0x0000ffff
    s_mov_b32 s63, 0x0000ffff
    s_nop 7
    v_lshlrev_b32 v3, 2, v1
    s_lshl_b32 s48, s57, 8
    s_add_u32 s49, s48, 0xe02000
    buffer_load_dword v14, v3, s[20:23], s49 offen sc1
    v_and_b32 v4, 7, v1
    v_lshlrev_b32 v4, 2, v4
    s_lshl_b32 s50, s58, 5
    s_add_u32 s49, s48, s50
    s_add_u32 s49, s49, 0xe00000
    buffer_load_dword v15, v4, s[20:23], s49 offen sc1
    buffer_load_dwordx4 v[72:75], v2, s[20:23], s59 offen sc1
    buffer_load_dwordx4 v[80:83], v2, s[20:23], s42 offen offset:0 sc1
    s_mov_b64 exec, s[62:63]
    buffer_load_dwordx4 a[0:3], v12, s[20:23], s43 offen offset:0 sc1
    buffer_load_dwordx4 a[4:7], v12, s[20:23], s43 offen offset:512 sc1
    s_mov_b64 exec, -1
    buffer_load_dwordx4 v[84:87], v2, s[20:23], s42 offen offset:1024 sc1
    s_mov_b64 exec, s[62:63]
    buffer_load_dwordx4 a[8:11], v12, s[20:23], s43 offen offset:1024 sc1
    buffer_load_dwordx4 a[12:15], v12, s[20:23], s43 offen offset:1536 sc1
    s_mov_b64 exec, -1
    buffer_load_dwordx4 v[88:91], v2, s[20:23], s42 offen offset:2048 sc1
    s_mov_b64 exec, s[62:63]
    buffer_load_dwordx4 a[16:19], v12, s[20:23], s43 offen offset:2048 sc1
    buffer_load_dwordx4 a[20:23], v12, s[20:23], s43 offen offset:2560 sc1
    s_mov_b64 exec, -1
    buffer_load_dwordx4 v[92:95], v2, s[20:23], s42 offen offset:3072 sc1
    s_add_u32 s42, s42, 4096
    s_mov_b64 exec, s[62:63]
    buffer_load_dwordx4 a[24:27], v12, s[20:23], s43 offen offset:3072 sc1
    buffer_load_dwordx4 a[28:31], v12, s[20:23], s43 offen offset:3584 sc1
    s_mov_b64 exec, -1
    s_add_u32 s43, s43, 4096
    buffer_load_dwordx4 v[96:99], v2, s[20:23], s42 offen offset:0 sc1
    s_mov_b64 exec, s[62:63]
    buffer_load_dwordx4 a[32:35], v12, s[20:23], s43 offen offset:0 sc1
    buffer_load_dwordx4 a[36:39], v12, s[20:23], s43 offen offset:512 sc1
    s_mov_b64 exec, -1
    buffer_load_dwordx4 v[100:103], v2, s[20:23], s42 offen offset:1024 sc1
    s_mov_b64 exec, s[62:63]
    buffer_load_dwordx4 a[40:43], v12, s[20:23], s43 offen offset:1024 sc1
    buffer_load_dwordx4 a[44:47], v12, s[20:23], s43 offen offset:1536 sc1
    s_mov_b64 exec, -1
    buffer_load_dwordx4 v[104:107], v2, s[20:23], s42 offen offset:2048 sc1
    s_mov_b64 exec, s[62:63]
    buffer_load_dwordx4 a[48:51], v12, s[20:23], s43 offen offset:2048 sc1
    buffer_load_dwordx4 a[52:55], v12, s[20:23], s43 offen offset:2560 sc1
    s_mov_b64 exec, -1
    buffer_load_dwordx4 v[108:111], v2, s[20:23], s42 offen offset:3072 sc1
    s_mov_b64 exec, s[62:63]
    buffer_load_dwordx4 a[56:59], v12, s[20:23], s43 offen offset:3072 sc1
    buffer_load_dwordx4 a[60:63], v12, s[20:23], s43 offen offset:3584 sc1
    s_mov_b64 exec, -1
    s_add_u32 s8, s84, 0x800000
    s_addc_u32 s9, s85, 0
    s_mov_b32 s10, 0x560000
    s_mov_b32 s11, 0x00020000
    s_mov_b32 s12, s76
    s_mov_b32 s13, s77
    s_mov_b32 s14, 0x158000
    s_mov_b32 s15, 0x00020000
    s_mov_b32 s16, s80
    s_mov_b32 s17, s81
    s_mov_b32 s18, 0x200000
    s_mov_b32 s19, 0x00020000
    s_waitcnt vmcnt(0)
    v_mov_b32 v3, v14
    v_mov_b32 v4, v15
    s_nop 0
    v_permlane32_swap_b32 v14, v3
    v_permlane32_swap_b32 v15, v4
    s_nop 0
    v_max_f32 v14, v14, v3
    v_max_f32 v15, v15, v4
    v_mov_b32 v3, v14
    v_mov_b32 v4, v15
    s_nop 0
    v_permlane16_swap_b32 v14, v3
    v_permlane16_swap_b32 v15, v4
    s_nop 0
    v_max_f32 v14, v14, v3
    v_max_f32 v15, v15, v4
    s_nop 0
    v_max_f32_dpp v14, v14, v14 row_ror:8 row_mask:0xf bank_mask:0xf
    v_max_f32_dpp v15, v15, v15 row_ror:8 row_mask:0xf bank_mask:0xf
    s_nop 0
    v_max_f32_dpp v14, v14, v14 row_ror:4 row_mask:0xf bank_mask:0xf
    v_max_f32_dpp v15, v15, v15 row_ror:4 row_mask:0xf bank_mask:0xf
    s_nop 0
    v_max_f32_dpp v14, v14, v14 row_ror:2 row_mask:0xf bank_mask:0xf
    v_max_f32_dpp v15, v15, v15 row_ror:2 row_mask:0xf bank_mask:0xf
    s_nop 0
    v_max_f32_dpp v14, v14, v14 row_ror:1 row_mask:0xf bank_mask:0xf
    v_max_f32_dpp v15, v15, v15 row_ror:1 row_mask:0xf bank_mask:0xf
    v_mul_f32 v14, v14, v15
    v_sqrt_f32 v14, v14
    v_mov_b32 v15, 0x42400000
    v_cmp_nle_f32 vcc, v14, v15
    v_sub_f32 v14, 0, v14
    s_nop 1
    s_cmp_lg_u64 vcc, 0
    s_cselect_b32 s60, 1, 0
    v_mov_b32 v48, v14
    v_mov_b32 v49, v14
    v_mov_b32 v50, v14
    v_mov_b32 v51, v14
    v_mov_b32 v52, v14
    v_mov_b32 v53, v14
    v_mov_b32 v54, v14
    v_mov_b32 v55, v14
    v_mov_b32 v56, v14
    v_mov_b32 v57, v14
    v_mov_b32 v58, v14
    v_mov_b32 v59, v14
    v_mov_b32 v60, v14
    v_mov_b32 v61, v14
    v_mov_b32 v62, v14
    v_mov_b32 v63, v14
A_DONE:
    s_branch K_ATT
K_B:
    v_lshrrev_b32 v3, 3, v1
    s_mul_i32 s48, s25, 16
    s_add_u32 s48, s48, 0
    v_add_u32 v3, s48, v3
    v_lshrrev_b32 v4, 1, v3
    v_and_b32 v4, 7, v4
    v_and_b32 v5, 7, v1
    v_xor_b32 v4, v4, v5
    v_lshlrev_b32 v4, 4, v4
    v_lshlrev_b32 v3, 10, v3
    v_add_u32 v14, v3, v4
    v_lshrrev_b32 v3, 3, v1
    s_mul_i32 s48, s25, 16
    s_add_u32 s48, s48, 8
    v_add_u32 v3, s48, v3
    v_lshrrev_b32 v4, 1, v3
    v_and_b32 v4, 7, v4
    v_and_b32 v5, 7, v1
    v_xor_b32 v4, v4, v5
    v_lshlrev_b32 v4, 4, v4
    v_lshlrev_b32 v3, 10, v3
    v_add_u32 v15, v3, v4
    v_lshrrev_b32 v3, 3, v1
    s_lshl_b32 s48, s25, 4
    v_add_u32 v3, s48, v3
    v_mul_u32_u24 v3, 3072, v3
    v_lshrrev_b32 v4, 4, v1
    v_and_b32 v4, 1, v4
    v_lshlrev_b32 v4, 2, v4
    v_and_b32 v5, 7, v1
    v_xor_b32 v4, v4, v5
    v_lshlrev_b32 v4, 4, v4
    v_add_u32 v16, v3, v4
    s_waitcnt lgkmcnt(0)
    s_mov_b32 s4, s64
    s_mov_b32 s5, s65
    s_mov_b32 s6, 0x200000
    s_mov_b32 s7, 0x00020000
    s_mov_b32 s8, s66
    s_mov_b32 s9, s67
    s_mov_b32 s10, 0x180000
    s_mov_b32 s11, 0x00020000
    s_mov_b32 s12, s72
    s_mov_b32 s13, s73
    s_mov_b32 s14, 0x158000
    s_mov_b32 s15, 0x00020000
    s_mov_b32 s16, s74
    s_mov_b32 s17, s75
    s_mov_b32 s18, 0x158000
    s_mov_b32 s19, 0x00020000
    s_mov_b32 s20, s84
    s_mov_b32 s21, s85
    s_mov_b32 s22, 0x1800000
    s_mov_b32 s23, 0x00020000
    s_mov_b32 s40, 0
    s_mov_b32 s39, 0
LD_PRO:
    s_lshl_b32 s42, s28, 7
    s_add_u32 s42, s42, s29
    s_mul_i32 s43, s28, 196608
    s_add_u32 s43, s43, s30
    s_add_u32 s44, s43, 24576
    s_add_u32 s45, s40, s31
    s_add_u32 s28, s28, 1
    s_and_b32 s28, s28, 7
    s_add_u32 m0, s45, 0
    s_nop 0
    buffer_load_dwordx4 v14, s[4:7], s42 offen lds
    s_add_u32 m0, s45, 1024
    s_nop 0
    buffer_load_dwordx4 v15, s[4:7], s42 offen lds
    s_add_u32 m0, s45, 8192
    s_nop 0
    buffer_load_dwordx4 v16, s[8:11], s43 offen lds
    s_add_u32 m0, s45, 9216
    s_nop 0
    buffer_load_dwordx4 v16, s[8:11], s44 offen lds
    s_add_u32 m0, s45, 15360
    s_nop 0
    buffer_load_dwordx4 v16, s[8:11], s43 offen offset:1024 lds
    s_add_u32 m0, s45, 16384
    s_nop 0
    buffer_load_dwordx4 v16, s[8:11], s44 offen offset:1024 lds
    s_add_u32 m0, s45, 22528
    s_nop 0
    buffer_load_dwordx4 v16, s[8:11], s43 offen offset:2048 lds
    s_add_u32 m0, s45, 23552
    s_nop 0
    buffer_load_dwordx4 v16, s[8:11], s44 offen offset:2048 lds
    s_add_u32 s40, s40, 40960
    s_cmp_eq_u32 s40, 163840
    s_cselect_b32 s40, 0, s40
    s_add_u32 s39, s39, 1
    s_cmp_lt_u32 s39, 2
    s_cbranch_scc1 LD_PRO
    v_lshrrev_b32 v3, 3, v1
    s_mul_i32 s48, s25, 32
    s_add_u32 s48, s48, 0
    v_add_u32 v3, s48, v3
    v_lshrrev_b32 v4, 1, v3
    v_and_b32 v4, 7, v4
    v_and_b32 v5, 7, v1
    v_xor_b32 v4, v4, v5
    v_lshlrev_b32 v4, 4, v4
    v_lshlrev_b32 v3, 10, v3
    v_add_u32 v17, v3, v4
    v_lshrrev_b32 v3, 3, v1
    s_mul_i32 s48, s25, 32
    s_add_u32 s48, s48, 8
    v_add_u32 v3, s48, v3
    v_lshrrev_b32 v4, 1, v3
    v_and_b32 v4, 7, v4
    v_and_b32 v5, 7, v1
    v_xor_b32 v4, v4, v5
    v_lshlrev_b32 v4, 4, v4
    v_lshlrev_b32 v3, 10, v3
    v_add_u32 v18, v3, v4
    v_lshrrev_b32 v3, 3, v1
    s_mul_i32 s48, s25, 32
    s_add_u32 s48, s48, 16
    v_add_u32 v3, s48, v3
    v_lshrrev_b32 v4, 1, v3
    v_and_b32 v4, 7, v4
    v_and_b32 v5, 7, v1
    v_xor_b32 v4, v4, v5
    v_lshlrev_b32 v4, 4, v4
    v_lshlrev_b32 v3, 10, v3
    v_add_u32 v19, v3, v4
    v_lshrrev_b32 v3, 3, v1
    s_mul_i32 s48, s25, 32
    s_add_u32 s48, s48, 24
    v_add_u32 v3, s48, v3
    v_lshrrev_b32 v4, 1, v3
    v_and_b32 v4, 7, v4
    v_and_b32 v5, 7, v1
    v_xor_b32 v4, v4, v5
    v_lshlrev_b32 v4, 4, v4
    v_lshlrev_b32 v3, 10, v3
    v_add_u32 v20, v3, v4
    v_add_u32 v3, 0, v1
    v_mul_u32_u24 v4, 171, v3
    v_lshrrev_b32 v4, 11, v4
    v_mul_u32_u24 v5, 12, v4
    v_sub_u32 v5, v3, v5
    s_lshl_b32 s48, s25, 4
    v_add_u32 v4, s48, v4
    v_mul_u32_u24 v4, 2752, v4
    v_lshlrev_b32 v5, 4, v5
    v_add_u32 v21, v4, v5
    v_add_u32 v3, 64, v1
    v_mul_u32_u24 v4, 171, v3
    v_lshrrev_b32 v4, 11, v4
    v_mul_u32_u24 v5, 12, v4
    v_sub_u32 v5, v3, v5
    s_lshl_b32 s48, s25, 4
    v_add_u32 v4, s48, v4
    v_mul_u32_u24 v4, 2752, v4
    v_lshlrev_b32 v5, 4, v5
    v_add_u32 v22, v4, v5
    v_add_u32 v3, 128, v1
    v_mul_u32_u24 v4, 171, v3
    v_lshrrev_b32 v4, 11, v4
    v_mul_u32_u24 v5, 12, v4
    v_sub_u32 v5, v3, v5
    s_lshl_b32 s48, s25, 4
    v_add_u32 v4, s48, v4
    v_mul_u32_u24 v4, 2752, v4
    v_lshlrev_b32 v5, 4, v5
    v_add_u32 v23, v4, v5
    v_and_b32 v3, 31, v1
    s_lshl_b32 s48, s25, 5
    v_add_u32 v3, s48, v3
    v_lshrrev_b32 v4, 1, v3
    v_and_b32 v4, 7, v4
    v_lshrrev_b32 v5, 5, v1
    v_xor_b32 v4, v4, v5
    v_lshlrev_b32 v3, 7, v3
    v_xor_b32 v5, 0, v4
    v_lshlrev_b32 v5, 4, v5
    v_add_u32 v24, v3, v5
    v_xor_b32 v5, 2, v4
    v_lshlrev_b32 v5, 4, v5
    v_add_u32 v25, v3, v5
    v_xor_b32 v5, 4, v4
    v_lshlrev_b32 v5, 4, v5
    v_add_u32 v26, v3, v5
    v_xor_b32 v5, 6, v4
    v_lshlrev_b32 v5, 4, v5
    v_add_u32 v27, v3, v5
    v_and_b32 v3, 15, v1
    v_lshrrev_b32 v3, 2, v3
    v_lshrrev_b32 v4, 5, v1
    v_lshlrev_b32 v4, 3, v4
    v_add_u32 v4, v4, v3
    v_mul_u32_u24 v4, 192, v4
    v_lshrrev_b32 v3, 4, v1
    v_and_b32 v3, 1, v3
    v_lshlrev_b32 v3, 5, v3
    v_add_u32 v4, v4, v3
    v_and_b32 v3, 3, v1
    v_lshlrev_b32 v3, 3, v3
    v_add_u32 v4, v4, v3
    v_mov_b32 v28, v4
    s_and_b32 s48, s2, 7
    s_lshr_b32 s49, s2, 3
    s_lshl_b32 s70, s48, 2
    s_and_b32 s50, s49, 3
    s_add_u32 s70, s70, s50
    s_lshr_b32 s71, s49, 2
    v_lshrrev_b32 v3, 3, v1
    v_lshlrev_b32 v3, 10, v3
    v_lshrrev_b32 v4, 4, v1
    v_and_b32 v4, 1, v4
    v_lshlrev_b32 v4, 2, v4
    v_and_b32 v5, 7, v1
    v_xor_b32 v4, v4, v5
    v_lshlrev_b32 v4, 4, v4
    v_add_u32 v7, v3, v4
    s_lshl_b32 s66, s24, 13
    s_add_u32 s66, s66, 73728
    v_and_b32 v3, 15, v1
    v_lshrrev_b32 v3, 2, v3
    v_lshrrev_b32 v4, 5, v1
    v_lshlrev_b32 v4, 2, v4
    v_add_u32 v4, v4, v3
    v_lshlrev_b32 v4, 7, v4
    v_lshrrev_b32 v3, 1, v3
    v_lshlrev_b32 v3, 6, v3
    v_add_u32 v4, v4, v3
    v_lshrrev_b32 v3, 4, v1
    v_and_b32 v3, 1, v3
    v_lshlrev_b32 v3, 5, v3
    v_add_u32 v4, v4, v3
    v_and_b32 v3, 3, v1
    v_lshlrev_b32 v3, 3, v3
    v_add_u32 v4, v4, v3
    v_add_u32 v8, s66, v4
    v_xor_b32 v9, 64, v8
    s_lshl_b32 s48, s70, 1
    s_and_b32 s49, s24, 1
    s_add_u32 s48, s48, s49
    s_mul_i32 s48, s48, 86
    s_lshr_b32 s49, s24, 1
    s_mul_i32 s49, s49, 22
    s_add_u32 s48, s48, s49
    s_lshl_b32 s72, s48, 10
    s_lshl_b32 s73, s49, 14
    s_lshl_b32 s50, s71, 7
    s_add_u32 s73, s73, s50
    s_add_u32 s74, s73, 8192
    s_lshl_b32 s75, s70, 7
    s_add_u32 s75, s75, 0xe11000
    v_and_b32 v11, 31, v1
    v_lshlrev_b32 v11, 2, v11
    s_lshl_b32 s48, s25, 3
    s_lshr_b32 s49, s24, 2
    s_lshl_b32 s49, s49, 2
    s_add_u32 s48, s48, s49
    s_mul_i32 s48, s48, 2304
    v_add_u32 v6, s48, v2
    v_lshlrev_b32 v0, 2, v1
    v_add_u32 v0, s48, v0
    s_waitcnt vmcnt(8)
    s_barrier
    s_lshl_b32 s42, s28, 7
    s_add_u32 s42, s42, s29
    s_mul_i32 s43, s28, 196608
    s_add_u32 s43, s43, s30
    s_add_u32 s44, s43, 24576
    s_add_u32 s45, s40, s31
    s_add_u32 s28, s28, 1
    s_and_b32 s28, s28, 7
    s_add_u32 m0, s45, 0
    s_nop 0
    buffer_load_dwordx4 v14, s[4:7], s42 offen lds
    s_add_u32 m0, s45, 1024
    s_nop 0
    buffer_load_dwordx4 v15, s[4:7], s42 offen lds
    s_add_u32 m0, s45, 8192
    s_nop 0
    buffer_load_dwordx4 v16, s[8:11], s43 offen lds
    s_add_u32 m0, s45, 9216
    s_nop 0
    buffer_load_dwordx4 v16, s[8:11], s44 offen lds
    s_add_u32 m0, s45, 15360
    s_nop 0
    buffer_load_dwordx4 v16, s[8:11], s43 offen offset:1024 lds
    s_add_u32 m0, s45, 16384
    s_nop 0
    buffer_load_dwordx4 v16, s[8:11], s44 offen offset:1024 lds
    s_add_u32 m0, s45, 22528
    s_nop 0
    buffer_load_dwordx4 v16, s[8:11], s43 offen offset:2048 lds
    s_add_u32 m0, s45, 23552
    s_nop 0
    buffer_load_dwordx4 v16, s[8:11], s44 offen offset:2048 lds
    s_add_u32 s40, s40, 40960
    s_cmp_eq_u32 s40, 163840
    s_cselect_b32 s40, 0, s40
    s_waitcnt vmcnt(8)
    s_barrier
    s_lshl_b32 s42, s28, 7
    s_add_u32 s42, s42, s29
    s_mul_i32 s43, s28, 196608
    s_add_u32 s43, s43, s30
    s_add_u32 s44, s43, 24576
    s_add_u32 s45, s40, s31
    s_add_u32 s28, s28, 1
    s_and_b32 s28, s28, 7
    s_add_u32 m0, s45, 0
    s_nop 0
    buffer_load_dwordx4 v14, s[4:7], s42 offen lds
    s_add_u32 m0, s45, 1024
    s_nop 0
    buffer_load_dwordx4 v15, s[4:7], s42 offen lds
    s_add_u32 m0, s45, 8192
    s_nop 0
    buffer_load_dwordx4 v16, s[8:11], s43 offen lds
    s_add_u32 m0, s45, 9216
    s_nop 0
    buffer_load_dwordx4 v16, s[8:11], s44 offen lds
    s_add_u32 m0, s45, 15360
    s_nop 0
    buffer_load_dwordx4 v16, s[8:11], s43 offen offset:1024 lds
    s_add_u32 m0, s45, 16384
    s_nop 0
    buffer_load_dwordx4 v16, s[8:11], s44 offen offset:1024 lds
    s_add_u32 m0, s45, 22528
    s_nop 0
    buffer_load_dwordx4 v16, s[8:11], s43 offen offset:2048 lds
    s_add_u32 m0, s45, 23552
    s_nop 0
    buffer_load_dwordx4 v16, s[8:11], s44 offen offset:2048 lds
    s_add_u32 s40, s40, 40960
    s_cmp_eq_u32 s40, 163840
    s_cselect_b32 s40, 0, s40
    s_mov_b32 s39, 0
LD_A:
    s_waitcnt vmcnt(8)
    s_barrier
    s_lshl_b32 s42, s28, 7
    s_add_u32 s42, s42, s29
    s_mul_i32 s43, s28, 196608
    s_add_u32 s43, s43, s30
    s_add_u32 s44, s43, 24576
    s_add_u32 s45, s40, s31
    s_add_u32 s28, s28, 1
    s_and_b32 s28, s28, 7
    s_add_u32 m0, s45, 0
    s_nop 0
    buffer_load_dwordx4 v14, s[4:7], s42 offen lds
    s_add_u32 m0, s45, 1024
    s_nop 0
    buffer_load_dwordx4 v15, s[4:7], s42 offen lds
    s_add_u32 m0, s45, 8192
    s_nop 0
    buffer_load_dwordx4 v16, s[8:11], s43 offen lds
    s_add_u32 m0, s45, 9216
    s_nop 0
    buffer_load_dwordx4 v16, s[8:11], s44 offen lds
    s_add_u32 m0, s45, 15360
    s_nop 0
    buffer_load_dwordx4 v16, s[8:11], s43 offen offset:1024 lds
    s_add_u32 m0, s45, 16384
    s_nop 0
    buffer_load_dwordx4 v16, s[8:11], s44 offen offset:1024 lds
    s_add_u32 m0, s45, 22528
    s_nop 0
    buffer_load_dwordx4 v16, s[8:11], s43 offen offset:2048 lds
    s_add_u32 m0, s45, 23552
    s_nop 0
    buffer_load_dwordx4 v16, s[8:11], s44 offen offset:2048 lds
    s_add_u32 s40, s40, 40960
    s_cmp_eq_u32 s40, 163840
    s_cselect_b32 s40, 0, s40
    s_add_u32 s39, s39, 1
    s_cmp_lt_u32 s39, 4
    s_cbranch_scc1 LD_A
    v_mov_b32 v5, 0
    global_load_dword v29, v5, s[82:83] sc1
    s_cmp_eq_u32 s33, 15
    s_cbranch_scc1 B_GATE
    s_waitcnt vmcnt(9)
    s_barrier
    s_lshl_b32 s42, s34, 7
    s_add_u32 s42, s42, s35
    s_mul_i32 s43, s34, 176128
    s_add_u32 s43, s43, s36
    s_add_u32 s45, s40, s37
    s_add_u32 s46, s40, s38
    s_add_u32 s34, s34, 1
    s_and_b32 s34, s34, 7
    s_add_u32 m0, s45, 0
    s_nop 0
    buffer_load_dwordx4 v17, s[4:7], s42 offen lds
    s_add_u32 m0, s45, 1024
    s_nop 0
    buffer_load_dwordx4 v18, s[4:7], s42 offen lds
    s_add_u32 m0, s45, 2048
    s_nop 0
    buffer_load_dwordx4 v19, s[4:7], s42 offen lds
    s_add_u32 m0, s45, 3072
    s_nop 0
    buffer_load_dwordx4 v20, s[4:7], s42 offen lds
    s_add_u32 m0, s46, 0
    s_nop 0
    buffer_load_dwordx4 v21, s[12:15], s43 offen lds
    s_add_u32 m0, s46, 1024
    s_nop 0
    buffer_load_dwordx4 v22, s[12:15], s43 offen lds
    s_add_u32 m0, s46, 2048
    s_nop 0
    buffer_load_dwordx4 v23, s[12:15], s43 offen lds
    s_add_u32 m0, s46, 12288
    s_nop 0
    buffer_load_dwordx4 v21, s[16:19], s43 offen lds
    s_add_u32 m0, s46, 13312
    s_nop 0
    buffer_load_dwordx4 v22, s[16:19], s43 offen lds
    s_add_u32 m0, s46, 14336
    s_nop 0
    buffer_load_dwordx4 v23, s[16:19], s43 offen lds
    s_add_u32 s40, s40, 40960
    s_cmp_eq_u32 s40, 163840
    s_cselect_b32 s40, 0, s40
    s_waitcnt vmcnt(10)
    s_barrier
    s_lshl_b32 s42, s34, 7
    s_add_u32 s42, s42, s35
    s_mul_i32 s43, s34, 176128
    s_add_u32 s43, s43, s36
    s_add_u32 s45, s40, s37
    s_add_u32 s46, s40, s38
    s_add_u32 s34, s34, 1
    s_and_b32 s34, s34, 7
    s_add_u32 m0, s45, 0
    s_nop 0
    buffer_load_dwordx4 v17, s[4:7], s42 offen lds
    s_add_u32 m0, s45, 1024
    s_nop 0
    buffer_load_dwordx4 v18, s[4:7], s42 offen lds
    s_add_u32 m0, s45, 2048
    s_nop 0
    buffer_load_dwordx4 v19, s[4:7], s42 offen lds
    s_add_u32 m0, s45, 3072
    s_nop 0
    buffer_load_dwordx4 v20, s[4:7], s42 offen lds
    s_add_u32 m0, s46, 0
    s_nop 0
    buffer_load_dwordx4 v21, s[12:15], s43 offen lds
    s_add_u32 m0, s46, 1024
    s_nop 0
    buffer_load_dwordx4 v22, s[12:15], s43 offen lds
    s_add_u32 m0, s46, 2048
    s_nop 0
    buffer_load_dwordx4 v23, s[12:15], s43 offen lds
    s_add_u32 m0, s46, 12288
    s_nop 0
    buffer_load_dwordx4 v21, s[16:19], s43 offen lds
    s_add_u32 m0, s46, 13312
    s_nop 0
    buffer_load_dwordx4 v22, s[16:19], s43 offen lds
    s_add_u32 m0, s46, 14336
    s_nop 0
    buffer_load_dwordx4 v23, s[16:19], s43 offen lds
    s_add_u32 s40, s40, 40960
    s_cmp_eq_u32 s40, 163840
    s_cselect_b32 s40, 0, s40
    s_waitcnt vmcnt(10)
    s_barrier
    v_readfirstlane_b32 s56, v29
    s_nop 3
    s_cmp_lg_u32 s56, 0
    s_cbranch_scc1 NONCE_OKb1
    s_mov_b32 s61, 0
    v_mov_b32 v4, 0
NONCE_Lb1:
    global_load_dword v3, v4, s[82:83] sc1
    s_waitcnt vmcnt(0)
    v_readfirstlane_b32 s56, v3
    s_add_u32 s61, s61, 1
    s_cmp_gt_u32 s61, 400000
    s_cbranch_scc1 NONCE_Db1
    s_cmp_eq_u32 s56, 0
    s_cbranch_scc1 NONCE_Lb1
NONCE_Db1:
NONCE_OKb1:
    s_mov_b32 s41, 0
    v_add_u32 v88, s41, v24
    v_add_u32 v89, s41, v25
    v_add_u32 v90, s41, v26
    v_add_u32 v91, s41, v27
    v_add_u32 v92, s41, v28
    ds_read_b128 v[32:35], v88
    ds_read_b64_tr_b16 v[40:41], v92 offset:16384
    ds_read_b64_tr_b16 v[42:43], v92 offset:17152
    ds_read_b64_tr_b16 v[44:45], v92 offset:16448
    ds_read_b64_tr_b16 v[46:47], v92 offset:17216
    ds_read_b64_tr_b16 v[48:49], v92 offset:16512
    ds_read_b64_tr_b16 v[50:51], v92 offset:17280
    ds_read_b64_tr_b16 v[52:53], v92 offset:28672
    ds_read_b64_tr_b16 v[54:55], v92 offset:29440
    ds_read_b64_tr_b16 v[56:57], v92 offset:28736
    ds_read_b64_tr_b16 v[58:59], v92 offset:29504
    ds_read_b64_tr_b16 v[60:61], v92 offset:28800
    ds_read_b64_tr_b16 v[62:63], v92 offset:29568
    s_waitcnt lgkmcnt(6)
    v_mfma_f32_32x32x16_bf16 v[96:111], v[40:43], v[32:35], 0
    ds_read_b128 v[36:39], v89
    ds_read_b64_tr_b16 v[64:65], v92 offset:19456
    v_mfma_f32_32x32x16_bf16 v[112:127], v[44:47], v[32:35], 0
    ds_read_b64_tr_b16 v[66:67], v92 offset:20224
    ds_read_b64_tr_b16 v[68:69], v92 offset:19520
    v_mfma_f32_32x32x16_bf16 v[128:143], v[48:51], v[32:35], 0
    ds_read_b64_tr_b16 v[70:71], v92 offset:20288
    ds_read_b64_tr_b16 v[72:73], v92 offset:19584
    ds_read_b64_tr_b16 v[74:75], v92 offset:20352
    s_waitcnt lgkmcnt(7)
    v_mfma_f32_32x32x16_bf16 v[144:159], v[52:55], v[32:35], 0
    ds_read_b64_tr_b16 v[76:77], v92 offset:31744
    ds_read_b64_tr_b16 v[78:79], v92 offset:32512
    v_mfma_f32_32x32x16_bf16 v[160:175], v[56:59], v[32:35], 0
    ds_read_b64_tr_b16 v[80:81], v92 offset:31808
    ds_read_b64_tr_b16 v[82:83], v92 offset:32576
    v_mfma_f32_32x32x16_bf16 v[176:191], v[60:63], v[32:35], 0
    ds_read_b64_tr_b16 v[84:85], v92 offset:31872
    ds_read_b64_tr_b16 v[86:87], v92 offset:32640
    s_waitcnt lgkmcnt(6)
    v_mfma_f32_32x32x16_bf16 v[96:111], v[64:67], v[36:39], v[96:111]
    ds_read_b128 v[32:35], v90
    ds_read_b64_tr_b16 v[40:41], v92 offset:22528
    v_mfma_f32_32x32x16_bf16 v[112:127], v[68:71], v[36:39], v[112:127]
    ds_read_b64_tr_b16 v[42:43], v92 offset:23296
    ds_read_b64_tr_b16 v[44:45], v92 offset:22592
    v_mfma_f32_32x32x16_bf16 v[128:143], v[72:75], v[36:39], v[128:143]
    ds_read_b64_tr_b16 v[46:47], v92 offset:23360
    ds_read_b64_tr_b16 v[48:49], v92 offset:22656
    ds_read_b64_tr_b16 v[50:51], v92 offset:23424
    s_waitcnt lgkmcnt(7)
    v_mfma_f32_32x32x16_bf16 v[144:159], v[76:79], v[36:39], v[144:159]
    ds_read_b64_tr_b16 v[52:53], v92 offset:34816
    ds_read_b64_tr_b16 v[54:55], v92 offset:35584
    v_mfma_f32_32x32x16_bf16 v[160:175], v[80:83], v[36:39], v[160:175]
    ds_read_b64_tr_b16 v[56:57], v92 offset:34880
    ds_read_b64_tr_b16 v[58:59], v92 offset:35648
    v_mfma_f32_32x32x16_bf16 v[176:191], v[84:87], v[36:39], v[176:191]
    ds_read_b64_tr_b16 v[60:61], v92 offset:34944
    ds_read_b64_tr_b16 v[62:63], v92 offset:35712
    s_waitcnt vmcnt(0)
    s_barrier
    s_waitcnt lgkmcnt(6)
    v_mfma_f32_32x32x16_bf16 v[96:111], v[40:43], v[32:35], v[96:111]
    ds_read_b128 v[36:39], v91
    ds_read_b64_tr_b16 v[64:65], v92 offset:25600
    v_mfma_f32_32x32x16_bf16 v[112:127], v[44:47], v[32:35], v[112:127]
    ds_read_b64_tr_b16 v[66:67], v92 offset:26368
    ds_read_b64_tr_b16 v[68:69], v92 offset:25664
    v_mfma_f32_32x32x16_bf16 v[128:143], v[48:51], v[32:35], v[128:143]
    ds_read_b64_tr_b16 v[70:71], v92 offset:26432
    ds_read_b64_tr_b16 v[72:73], v92 offset:25728
    ds_read_b64_tr_b16 v[74:75], v92 offset:26496
    s_waitcnt lgkmcnt(7)
    v_mfma_f32_32x32x16_bf16 v[144:159], v[52:55], v[32:35], v[144:159]
    ds_read_b64_tr_b16 v[76:77], v92 offset:37888
    ds_read_b64_tr_b16 v[78:79], v92 offset:38656
    v_mfma_f32_32x32x16_bf16 v[160:175], v[56:59], v[32:35], v[160:175]
    ds_read_b64_tr_b16 v[80:81], v92 offset:37952
    ds_read_b64_tr_b16 v[82:83], v92 offset:38720
    v_mfma_f32_32x32x16_bf16 v[176:191], v[60:63], v[32:35], v[176:191]
    ds_read_b64_tr_b16 v[84:85], v92 offset:38016
    ds_read_b64_tr_b16 v[86:87], v92 offset:38784
    s_add_u32 s41, s41, 40960
    s_cmp_eq_u32 s41, 163840
    s_cselect_b32 s41, 0, s41
    v_add_u32 v88, s41, v24
    v_add_u32 v89, s41, v25
    v_add_u32 v90, s41, v26
    v_add_u32 v91, s41, v27
    v_add_u32 v92, s41, v28
    s_waitcnt lgkmcnt(6)
    v_mfma_f32_32x32x16_bf16 v[96:111], v[64:67], v[36:39], v[96:111]
    ds_read_b128 v[32:35], v88
    ds_read_b64_tr_b16 v[40:41], v92 offset:16384
    v_mfma_f32_32x32x16_bf16 v[112:127], v[68:71], v[36:39], v[112:127]
    ds_read_b64_tr_b16 v[42:43], v92 offset:17152
    ds_read_b64_tr_b16 v[44:45], v92 offset:16448
    v_mfma_f32_32x32x16_bf16 v[128:143], v[72:75], v[36:39], v[128:143]
    ds_read_b64_tr_b16 v[46:47], v92 offset:17216
    ds_read_b64_tr_b16 v[48:49], v92 offset:16512
    ds_read_b64_tr_b16 v[50:51], v92 offset:17280
    s_waitcnt lgkmcnt(7)
    v_mfma_f32_32x32x16_bf16 v[144:159], v[76:79], v[36:39], v[144:159]
    ds_read_b64_tr_b16 v[52:53], v92 offset:28672
    ds_read_b64_tr_b16 v[54:55], v92 offset:29440
    v_mfma_f32_32x32x16_bf16 v[160:175], v[80:83], v[36:39], v[160:175]
    ds_read_b64_tr_b16 v[56:57], v92 offset:28736
    ds_read_b64_tr_b16 v[58:59], v92 offset:29504
    v_mfma_f32_32x32x16_bf16 v[176:191], v[84:87], v[36:39], v[176:191]
    ds_read_b64_tr_b16 v[60:61], v92 offset:28800
    ds_read_b64_tr_b16 v[62:63], v92 offset:29568
    s_mov_b32 s39, 0
P2_L:
    s_waitcnt lgkmcnt(6)
    v_mfma_f32_32x32x16_bf16 v[96:111], v[40:43], v[32:35], v[96:111]
    ds_read_b128 v[36:39], v89
    ds_read_b64_tr_b16 v[64:65], v92 offset:19456
    v_mfma_f32_32x32x16_bf16 v[112:127], v[44:47], v[32:35], v[112:127]
    ds_read_b64_tr_b16 v[66:67], v92 offset:20224
    ds_read_b64_tr_b16 v[68:69], v92 offset:19520
    v_mfma_f32_32x32x16_bf16 v[128:143], v[48:51], v[32:35], v[128:143]
    ds_read_b64_tr_b16 v[70:71], v92 offset:20288
    ds_read_b64_tr_b16 v[72:73], v92 offset:19584
    ds_read_b64_tr_b16 v[74:75], v92 offset:20352
    s_waitcnt lgkmcnt(7)
    v_mfma_f32_32x32x16_bf16 v[144:159], v[52:55], v[32:35], v[144:159]
    ds_read_b64_tr_b16 v[76:77], v92 offset:31744
    ds_read_b64_tr_b16 v[78:79], v92 offset:32512
    v_mfma_f32_32x32x16_bf16 v[160:175], v[56:59], v[32:35], v[160:175]
    ds_read_b64_tr_b16 v[80:81], v92 offset:31808
    ds_read_b64_tr_b16 v[82:83], v92 offset:32576
    v_mfma_f32_32x32x16_bf16 v[176:191], v[60:63], v[32:35], v[176:191]
    ds_read_b64_tr_b16 v[84:85], v92 offset:31872
    ds_read_b64_tr_b16 v[86:87], v92 offset:32640
    s_waitcnt lgkmcnt(6)
    v_mfma_f32_32x32x16_bf16 v[96:111], v[64:67], v[36:39], v[96:111]
    ds_read_b128 v[32:35], v90
    ds_read_b64_tr_b16 v[40:41], v92 offset:22528
    v_mfma_f32_32x32x16_bf16 v[112:127], v[68:71], v[36:39], v[112:127]
    ds_read_b64_tr_b16 v[42:43], v92 offset:23296
    ds_read_b64_tr_b16 v[44:45], v92 offset:22592
    v_mfma_f32_32x32x16_bf16 v[128:143], v[72:75], v[36:39], v[128:143]
    ds_read_b64_tr_b16 v[46:47], v92 offset:23360
    ds_read_b64_tr_b16 v[48:49], v92 offset:22656
    ds_read_b64_tr_b16 v[50:51], v92 offset:23424
    s_waitcnt lgkmcnt(7)
    v_mfma_f32_32x32x16_bf16 v[144:159], v[76:79], v[36:39], v[144:159]
    ds_read_b64_tr_b16 v[52:53], v92 offset:34816
    ds_read_b64_tr_b16 v[54:55], v92 offset:35584
    v_mfma_f32_32x32x16_bf16 v[160:175], v[80:83], v[36:39], v[160:175]
    ds_read_b64_tr_b16 v[56:57], v92 offset:34880
    ds_read_b64_tr_b16 v[58:59], v92 offset:35648
    v_mfma_f32_32x32x16_bf16 v[176:191], v[84:87], v[36:39], v[176:191]
    ds_read_b64_tr_b16 v[60:61], v92 offset:34944
    ds_read_b64_tr_b16 v[62:63], v92 offset:35712
    s_barrier
    s_waitcnt lgkmcnt(6)
    v_mfma_f32_32x32x16_bf16 v[96:111], v[40:43], v[32:35], v[96:111]
    ds_read_b128 v[36:39], v91
    ds_read_b64_tr_b16 v[64:65], v92 offset:25600
    v_mfma_f32_32x32x16_bf16 v[112:127], v[44:47], v[32:35], v[112:127]
    ds_read_b64_tr_b16 v[66:67], v92 offset:26368
    ds_read_b64_tr_b16 v[68:69], v92 offset:25664
    v_mfma_f32_32x32x16_bf16 v[128:143], v[48:51], v[32:35], v[128:143]
    ds_read_b64_tr_b16 v[70:71], v92 offset:26432
    ds_read_b64_tr_b16 v[72:73], v92 offset:25728
    ds_read_b64_tr_b16 v[74:75], v92 offset:26496
    s_waitcnt lgkmcnt(7)
    v_mfma_f32_32x32x16_bf16 v[144:159], v[52:55], v[32:35], v[144:159]
    ds_read_b64_tr_b16 v[76:77], v92 offset:37888
    ds_read_b64_tr_b16 v[78:79], v92 offset:38656
    v_mfma_f32_32x32x16_bf16 v[160:175], v[56:59], v[32:35], v[160:175]
    ds_read_b64_tr_b16 v[80:81], v92 offset:37952
    ds_read_b64_tr_b16 v[82:83], v92 offset:38720
    v_mfma_f32_32x32x16_bf16 v[176:191], v[60:63], v[32:35], v[176:191]
    ds_read_b64_tr_b16 v[84:85], v92 offset:38016
    ds_read_b64_tr_b16 v[86:87], v92 offset:38784
    s_add_u32 s41, s41, 40960
    s_cmp_eq_u32 s41, 163840
    s_cselect_b32 s41, 0, s41
    v_add_u32 v88, s41, v24
    v_add_u32 v89, s41, v25
    v_add_u32 v90, s41, v26
    v_add_u32 v91, s41, v27
    v_add_u32 v92, s41, v28
    s_waitcnt lgkmcnt(6)
    v_mfma_f32_32x32x16_bf16 v[96:111], v[64:67], v[36:39], v[96:111]
    ds_read_b128 v[32:35], v88
    ds_read_b64_tr_b16 v[40:41], v92 offset:16384
    v_mfma_f32_32x32x16_bf16 v[112:127], v[68:71], v[36:39], v[112:127]
    ds_read_b64_tr_b16 v[42:43], v92 offset:17152
    ds_read_b64_tr_b16 v[44:45], v92 offset:16448
    v_mfma_f32_32x32x16_bf16 v[128:143], v[72:75], v[36:39], v[128:143]
    ds_read_b64_tr_b16 v[46:47], v92 offset:17216
    ds_read_b64_tr_b16 v[48:49], v92 offset:16512
    ds_read_b64_tr_b16 v[50:51], v92 offset:17280
    s_waitcnt lgkmcnt(7)
    v_mfma_f32_32x32x16_bf16 v[144:159], v[76:79], v[36:39], v[144:159]
    ds_read_b64_tr_b16 v[52:53], v92 offset:28672
    ds_read_b64_tr_b16 v[54:55], v92 offset:29440
    v_mfma_f32_32x32x16_bf16 v[160:175], v[80:83], v[36:39], v[160:175]
    ds_read_b64_tr_b16 v[56:57], v92 offset:28736
    ds_read_b64_tr_b16 v[58:59], v92 offset:29504
    v_mfma_f32_32x32x16_bf16 v[176:191], v[84:87], v[36:39], v[176:191]
    ds_read_b64_tr_b16 v[60:61], v92 offset:28800
    ds_read_b64_tr_b16 v[62:63], v92 offset:29568
    s_add_u32 s39, s39, 1
    s_cmp_lt_u32 s39, 7
    s_cbranch_scc1 P2_L
    s_waitcnt lgkmcnt(0)
    s_add_u32 s8, s84, 0x800000
    s_addc_u32 s9, s85, 0
    s_mov_b32 s10, 0x560000
    s_mov_b32 s11, 0x00020000
    s_mov_b32 s12, s76
    s_mov_b32 s13, s77
    s_mov_b32 s14, 0x158000
    s_mov_b32 s15, 0x00020000
    s_mov_b32 s16, s80
    s_mov_b32 s17, s81
    s_mov_b32 s18, 0x200000
    s_mov_b32 s19, 0x00020000
    s_barrier
    s_branch B_C1
B_GATE:
    s_waitcnt vmcnt(9)
    s_barrier
    s_waitcnt vmcnt(0)
    s_barrier
    s_barrier
    v_readfirstlane_b32 s56, v29
    s_nop 3
    s_cmp_lg_u32 s56, 0
    s_cbranch_scc1 NONCE_OKb2
    s_mov_b32 s61, 0
    v_mov_b32 v4, 0
NONCE_Lb2:
    global_load_dword v3, v4, s[82:83] sc1
    s_waitcnt vmcnt(0)
    v_readfirstlane_b32 s56, v3
    s_add_u32 s61, s61, 1
    s_cmp_gt_u32 s61, 400000
    s_cbranch_scc1 NONCE_Db2
    s_cmp_eq_u32 s56, 0
    s_cbranch_scc1 NONCE_Lb2
NONCE_Db2:
NONCE_OKb2:
    s_add_u32 s8, s84, 0x800000
    s_addc_u32 s9, s85, 0
    s_mov_b32 s10, 0x560000
    s_mov_b32 s11, 0x00020000
    s_mov_b32 s12, s76
    s_mov_b32 s13, s77
    s_mov_b32 s14, 0x158000
    s_mov_b32 s15, 0x00020000
    s_mov_b32 s16, s80
    s_mov_b32 s17, s81
    s_mov_b32 s18, 0x200000
    s_mov_b32 s19, 0x00020000
    s_barrier
    s_mov_b32 s44, s78
    s_mov_b32 s45, s79
    s_mov_b32 s46, 0x400
    s_mov_b32 s47, 0x00020000
    buffer_load_dwordx4 v[160:163], v2, s[44:47], 0 offen
    s_lshl_b32 s48, s32, 7
    s_lshl_b32 s49, s25, 5
    s_add_u32 s48, s48, s49
    s_lshl_b32 s49, s48, 10
    buffer_load_dwordx4 v[32:35], v2, s[4:7], s49 offen offset:0
    buffer_load_dwordx4 v[36:39], v2, s[4:7], s49 offen offset:1024
    buffer_load_dwordx4 v[40:43], v2, s[4:7], s49 offen offset:2048
    buffer_load_dwordx4 v[44:47], v2, s[4:7], s49 offen offset:3072
    s_add_u32 s49, s49, 4096
    buffer_load_dwordx4 v[48:51], v2, s[4:7], s49 offen offset:0
    buffer_load_dwordx4 v[52:55], v2, s[4:7], s49 offen offset:1024
    buffer_load_dwordx4 v[56:59], v2, s[4:7], s49 offen offset:2048
    buffer_load_dwordx4 v[60:63], v2, s[4:7], s49 offen offset:3072
    s_add_u32 s49, s49, 4096
    buffer_load_dwordx4 v[64:67], v2, s[4:7], s49 offen offset:0
    buffer_load_dwordx4 v[68:71], v2, s[4:7], s49 offen offset:1024
    buffer_load_dwordx4 v[72:75], v2, s[4:7], s49 offen offset:2048
    buffer_load_dwordx4 v[76:79], v2, s[4:7], s49 offen offset:3072
    s_add_u32 s49, s49, 4096
    buffer_load_dwordx4 v[80:83], v2, s[4:7], s49 offen offset:0
    buffer_load_dwordx4 v[84:87], v2, s[4:7], s49 offen offset:1024
    buffer_load_dwordx4 v[88:91], v2, s[4:7], s49 offen offset:2048
    buffer_load_dwordx4 v[92:95], v2, s[4:7], s49 offen offset:3072
    s_add_u32 s49, s49, 4096
    buffer_load_dwordx4 v[96:99], v2, s[4:7], s49 offen offset:0
    buffer_load_dwordx4 v[100:103], v2, s[4:7], s49 offen offset:1024
    buffer_load_dwordx4 v[104:107], v2, s[4:7], s49 offen offset:2048
    buffer_load_dwordx4 v[108:111], v2, s[4:7], s49 offen offset:3072
    s_add_u32 s49, s49, 4096
    buffer_load_dwordx4 v[112:115], v2, s[4:7], s49 offen offset:0
    buffer_load_dwordx4 v[116:119], v2, s[4:7], s49 offen offset:1024
    buffer_load_dwordx4 v[120:123], v2, s[4:7], s49 offen offset:2048
    buffer_load_dwordx4 v[124:127], v2, s[4:7], s49 offen offset:3072
    s_add_u32 s49, s49, 4096
    buffer_load_dwordx4 v[128:131], v2, s[4:7], s49 offen offset:0
    buffer_load_dwordx4 v[132:135], v2, s[4:7], s49 offen offset:1024
    buffer_load_dwordx4 v[136:139], v2, s[4:7], s49 offen offset:2048
    buffer_load_dwordx4 v[140:143], v2, s[4:7], s49 offen offset:3072
    s_add_u32 s49, s49, 4096
    buffer_load_dwordx4 v[144:147], v2, s[4:7], s49 offen offset:0
    buffer_load_dwordx4 v[148:151], v2, s[4:7], s49 offen offset:1024
    buffer_load_dwordx4 v[152:155], v2, s[4:7], s49 offen offset:2048
    buffer_load_dwordx4 v[156:159], v2, s[4:7], s49 offen offset:3072
    s_add_u32 s49, s49, 4096
    s_mov_b32 s52, 0xbfb8aa3b
    s_lshl_b32 s49, s48, 2
    s_add_u32 s49, s49, 0xe04000
    v_mov_b32 v3, 0
    s_waitcnt vmcnt(24)
    v_dot2_f32_bf16 v164, v32, v160, 0
    v_dot2_f32_bf16 v165, v36, v160, 0
    v_dot2_f32_bf16 v166, v40, v160, 0
    v_dot2_f32_bf16 v167, v44, v160, 0
    v_dot2_f32_bf16 v168, v48, v160, 0
    v_dot2_f32_bf16 v169, v52, v160, 0
    v_dot2_f32_bf16 v170, v56, v160, 0
    v_dot2_f32_bf16 v171, v60, v160, 0
    v_dot2_f32_bf16 v164, v33, v161, v164
    v_dot2_f32_bf16 v165, v37, v161, v165
    v_dot2_f32_bf16 v166, v41, v161, v166
    v_dot2_f32_bf16 v167, v45, v161, v167
    v_dot2_f32_bf16 v168, v49, v161, v168
    v_dot2_f32_bf16 v169, v53, v161, v169
    v_dot2_f32_bf16 v170, v57, v161, v170
    v_dot2_f32_bf16 v171, v61, v161, v171
    v_dot2_f32_bf16 v164, v34, v162, v164
    v_dot2_f32_bf16 v165, v38, v162, v165
    v_dot2_f32_bf16 v166, v42, v162, v166
    v_dot2_f32_bf16 v167, v46, v162, v167
    v_dot2_f32_bf16 v168, v50, v162, v168
    v_dot2_f32_bf16 v169, v54, v162, v169
    v_dot2_f32_bf16 v170, v58, v162, v170
    v_dot2_f32_bf16 v171, v62, v162, v171
    v_dot2_f32_bf16 v164, v35, v163, v164
    v_dot2_f32_bf16 v165, v39, v163, v165
    v_dot2_f32_bf16 v166, v43, v163, v166
    v_dot2_f32_bf16 v167, v47, v163, v167
    v_dot2_f32_bf16 v168, v51, v163, v168
    v_dot2_f32_bf16 v169, v55, v163, v169
    v_dot2_f32_bf16 v170, v59, v163, v170
    v_dot2_f32_bf16 v171, v63, v163, v171
    s_nop 2
    v_mov_b32 v172, v164
    v_mov_b32 v173, v165
    v_mov_b32 v174, v166
    v_mov_b32 v175, v167
    v_mov_b32 v176, v168
    v_mov_b32 v177, v169
    v_mov_b32 v178, v170
    v_mov_b32 v179, v171
    v_permlane32_swap_b32 v164, v172
    v_permlane32_swap_b32 v165, v173
    v_permlane32_swap_b32 v166, v174
    v_permlane32_swap_b32 v167, v175
    v_permlane32_swap_b32 v168, v176
    v_permlane32_swap_b32 v169, v177
    v_permlane32_swap_b32 v170, v178
    v_permlane32_swap_b32 v171, v179
    s_nop 0
    v_add_f32 v164, v164, v172
    v_add_f32 v165, v165, v173
    v_add_f32 v166, v166, v174
    v_add_f32 v167, v167, v175
    v_add_f32 v168, v168, v176
    v_add_f32 v169, v169, v177
    v_add_f32 v170, v170, v178
    v_add_f32 v171, v171, v179
    v_mov_b32 v172, v164
    v_mov_b32 v173, v165
    v_mov_b32 v174, v166
    v_mov_b32 v175, v167
    v_mov_b32 v176, v168
    v_mov_b32 v177, v169
    v_mov_b32 v178, v170
    v_mov_b32 v179, v171
    v_permlane16_swap_b32 v164, v172
    v_permlane16_swap_b32 v165, v173
    v_permlane16_swap_b32 v166, v174
    v_permlane16_swap_b32 v167, v175
    v_permlane16_swap_b32 v168, v176
    v_permlane16_swap_b32 v169, v177
    v_permlane16_swap_b32 v170, v178
    v_permlane16_swap_b32 v171, v179
    s_nop 0
    v_add_f32 v164, v164, v172
    v_add_f32 v165, v165, v173
    v_add_f32 v166, v166, v174
    v_add_f32 v167, v167, v175
    v_add_f32 v168, v168, v176
    v_add_f32 v169, v169, v177
    v_add_f32 v170, v170, v178
    v_add_f32 v171, v171, v179
    v_add_f32_dpp v164, v164, v164 row_ror:8 row_mask:0xf bank_mask:0xf
    v_add_f32_dpp v165, v165, v165 row_ror:8 row_mask:0xf bank_mask:0xf
    v_add_f32_dpp v166, v166, v166 row_ror:8 row_mask:0xf bank_mask:0xf
    v_add_f32_dpp v167, v167, v167 row_ror:8 row_mask:0xf bank_mask:0xf
    v_add_f32_dpp v168, v168, v168 row_ror:8 row_mask:0xf bank_mask:0xf
    v_add_f32_dpp v169, v169, v169 row_ror:8 row_mask:0xf bank_mask:0xf
    v_add_f32_dpp v170, v170, v170 row_ror:8 row_mask:0xf bank_mask:0xf
    v_add_f32_dpp v171, v171, v171 row_ror:8 row_mask:0xf bank_mask:0xf
    v_add_f32_dpp v164, v164, v164 row_ror:4 row_mask:0xf bank_mask:0xf
    v_add_f32_dpp v165, v165, v165 row_ror:4 row_mask:0xf bank_mask:0xf
    v_add_f32_dpp v166, v166, v166 row_ror:4 row_mask:0xf bank_mask:0xf
    v_add_f32_dpp v167, v167, v167 row_ror:4 row_mask:0xf bank_mask:0xf
    v_add_f32_dpp v168, v168, v168 row_ror:4 row_mask:0xf bank_mask:0xf
    v_add_f32_dpp v169, v169, v169 row_ror:4 row_mask:0xf bank_mask:0xf
    v_add_f32_dpp v170, v170, v170 row_ror:4 row_mask:0xf bank_mask:0xf
    v_add_f32_dpp v171, v171, v171 row_ror:4 row_mask:0xf bank_mask:0xf
    v_add_f32_dpp v164, v164, v164 row_ror:2 row_mask:0xf bank_mask:0xf
    v_add_f32_dpp v165, v165, v165 row_ror:2 row_mask:0xf bank_mask:0xf
    v_add_f32_dpp v166, v166, v166 row_ror:2 row_mask:0xf bank_mask:0xf
    v_add_f32_dpp v167, v167, v167 row_ror:2 row_mask:0xf bank_mask:0xf
    v_add_f32_dpp v168, v168, v168 row_ror:2 row_mask:0xf bank_mask:0xf
    v_add_f32_dpp v169, v169, v169 row_ror:2 row_mask:0xf bank_mask:0xf
    v_add_f32_dpp v170, v170, v170 row_ror:2 row_mask:0xf bank_mask:0xf
    v_add_f32_dpp v171, v171, v171 row_ror:2 row_mask:0xf bank_mask:0xf
    v_add_f32_dpp v164, v164, v164 row_ror:1 row_mask:0xf bank_mask:0xf
    v_add_f32_dpp v165, v165, v165 row_ror:1 row_mask:0xf bank_mask:0xf
    v_add_f32_dpp v166, v166, v166 row_ror:1 row_mask:0xf bank_mask:0xf
    v_add_f32_dpp v167, v167, v167 row_ror:1 row_mask:0xf bank_mask:0xf
    v_add_f32_dpp v168, v168, v168 row_ror:1 row_mask:0xf bank_mask:0xf
    v_add_f32_dpp v169, v169, v169 row_ror:1 row_mask:0xf bank_mask:0xf
    v_add_f32_dpp v170, v170, v170 row_ror:1 row_mask:0xf bank_mask:0xf
    v_add_f32_dpp v171, v171, v171 row_ror:1 row_mask:0xf bank_mask:0xf
    v_mul_f32 v164, s52, v164
    v_mul_f32 v165, s52, v165
    v_mul_f32 v166, s52, v166
    v_mul_f32 v167, s52, v167
    v_mul_f32 v168, s52, v168
    v_mul_f32 v169, s52, v169
    v_mul_f32 v170, s52, v170
    v_mul_f32 v171, s52, v171
    v_exp_f32 v164, v164
    v_exp_f32 v165, v165
    v_exp_f32 v166, v166
    v_exp_f32 v167, v167
    v_exp_f32 v168, v168
    v_exp_f32 v169, v169
    v_exp_f32 v170, v170
    v_exp_f32 v171, v171
    v_add_f32 v164, 1.0, v164
    v_add_f32 v165, 1.0, v165
    v_add_f32 v166, 1.0, v166
    v_add_f32 v167, 1.0, v167
    v_add_f32 v168, 1.0, v168
    v_add_f32 v169, 1.0, v169
    v_add_f32 v170, 1.0, v170
    v_add_f32 v171, 1.0, v171
    v_rcp_f32 v164, v164
    v_rcp_f32 v165, v165
    v_rcp_f32 v166, v166
    v_rcp_f32 v167, v167
    v_rcp_f32 v168, v168
    v_rcp_f32 v169, v169
    v_rcp_f32 v170, v170
    v_rcp_f32 v171, v171
    s_mov_b64 exec, 1
    buffer_store_dword v164, v3, s[20:23], s49 offen offset:0 sc1
    buffer_store_dword v165, v3, s[20:23], s49 offen offset:4 sc1
    buffer_store_dword v166, v3, s[20:23], s49 offen offset:8 sc1
    buffer_store_dword v167, v3, s[20:23], s49 offen offset:12 sc1
    buffer_store_dword v168, v3, s[20:23], s49 offen offset:16 sc1
    buffer_store_dword v169, v3, s[20:23], s49 offen offset:20 sc1
    buffer_store_dword v170, v3, s[20:23], s49 offen offset:24 sc1
    buffer_store_dword v171, v3, s[20:23], s49 offen offset:28 sc1
    s_mov_b64 exec, -1
    s_nop 1
    s_waitcnt vmcnt(24)
    v_dot2_f32_bf16 v164, v64, v160, 0
    v_dot2_f32_bf16 v165, v68, v160, 0
    v_dot2_f32_bf16 v166, v72, v160, 0
    v_dot2_f32_bf16 v167, v76, v160, 0
    v_dot2_f32_bf16 v168, v80, v160, 0
    v_dot2_f32_bf16 v169, v84, v160, 0
    v_dot2_f32_bf16 v170, v88, v160, 0
    v_dot2_f32_bf16 v171, v92, v160, 0
    v_dot2_f32_bf16 v164, v65, v161, v164
    v_dot2_f32_bf16 v165, v69, v161, v165
    v_dot2_f32_bf16 v166, v73, v161, v166
    v_dot2_f32_bf16 v167, v77, v161, v167
    v_dot2_f32_bf16 v168, v81, v161, v168
    v_dot2_f32_bf16 v169, v85, v161, v169
    v_dot2_f32_bf16 v170, v89, v161, v170
    v_dot2_f32_bf16 v171, v93, v161, v171
    v_dot2_f32_bf16 v164, v66, v162, v164
    v_dot2_f32_bf16 v165, v70, v162, v165
    v_dot2_f32_bf16 v166, v74, v162, v166
    v_dot2_f32_bf16 v167, v78, v162, v167
    v_dot2_f32_bf16 v168, v82, v162, v168
    v_dot2_f32_bf16 v169, v86, v162, v169
    v_dot2_f32_bf16 v170, v90, v162, v170
    v_dot2_f32_bf16 v171, v94, v162, v171
    v_dot2_f32_bf16 v164, v67, v163, v164
    v_dot2_f32_bf16 v165, v71, v163, v165
    v_dot2_f32_bf16 v166, v75, v163, v166
    v_dot2_f32_bf16 v167, v79, v163, v167
    v_dot2_f32_bf16 v168, v83, v163, v168
    v_dot2_f32_bf16 v169, v87, v163, v169
    v_dot2_f32_bf16 v170, v91, v163, v170
    v_dot2_f32_bf16 v171, v95, v163, v171
    s_nop 2
    v_mov_b32 v172, v164
    v_mov_b32 v173, v165
    v_mov_b32 v174, v166
    v_mov_b32 v175, v167
    v_mov_b32 v176, v168
    v_mov_b32 v177, v169
    v_mov_b32 v178, v170
    v_mov_b32 v179, v171
    v_permlane32_swap_b32 v164, v172
    v_permlane32_swap_b32 v165, v173
    v_permlane32_swap_b32 v166, v174
    v_permlane32_swap_b32 v167, v175
    v_permlane32_swap_b32 v168, v176
    v_permlane32_swap_b32 v169, v177
    v_permlane32_swap_b32 v170, v178
    v_permlane32_swap_b32 v171, v179
    s_nop 0
    v_add_f32 v164, v164, v172
    v_add_f32 v165, v165, v173
    v_add_f32 v166, v166, v174
    v_add_f32 v167, v167, v175
    v_add_f32 v168, v168, v176
    v_add_f32 v169, v169, v177
    v_add_f32 v170, v170, v178
    v_add_f32 v171, v171, v179
    v_mov_b32 v172, v164
    v_mov_b32 v173, v165
    v_mov_b32 v174, v166
    v_mov_b32 v175, v167
    v_mov_b32 v176, v168
    v_mov_b32 v177, v169
    v_mov_b32 v178, v170
    v_mov_b32 v179, v171
    v_permlane16_swap_b32 v164, v172
    v_permlane16_swap_b32 v165, v173
    v_permlane16_swap_b32 v166, v174
    v_permlane16_swap_b32 v167, v175
    v_permlane16_swap_b32 v168, v176
    v_permlane16_swap_b32 v169, v177
    v_permlane16_swap_b32 v170, v178
    v_permlane16_swap_b32 v171, v179
    s_nop 0
    v_add_f32 v164, v164, v172
    v_add_f32 v165, v165, v173
    v_add_f32 v166, v166, v174
    v_add_f32 v167, v167, v175
    v_add_f32 v168, v168, v176
    v_add_f32 v169, v169, v177
    v_add_f32 v170, v170, v178
    v_add_f32 v171, v171, v179
    v_add_f32_dpp v164, v164, v164 row_ror:8 row_mask:0xf bank_mask:0xf
    v_add_f32_dpp v165, v165, v165 row_ror:8 row_mask:0xf bank_mask:0xf
    v_add_f32_dpp v166, v166, v166 row_ror:8 row_mask:0xf bank_mask:0xf
    v_add_f32_dpp v167, v167, v167 row_ror:8 row_mask:0xf bank_mask:0xf
    v_add_f32_dpp v168, v168, v168 row_ror:8 row_mask:0xf bank_mask:0xf
    v_add_f32_dpp v169, v169, v169 row_ror:8 row_mask:0xf bank_mask:0xf
    v_add_f32_dpp v170, v170, v170 row_ror:8 row_mask:0xf bank_mask:0xf
    v_add_f32_dpp v171, v171, v171 row_ror:8 row_mask:0xf bank_mask:0xf
    v_add_f32_dpp v164, v164, v164 row_ror:4 row_mask:0xf bank_mask:0xf
    v_add_f32_dpp v165, v165, v165 row_ror:4 row_mask:0xf bank_mask:0xf
    v_add_f32_dpp v166, v166, v166 row_ror:4 row_mask:0xf bank_mask:0xf
    v_add_f32_dpp v167, v167, v167 row_ror:4 row_mask:0xf bank_mask:0xf
    v_add_f32_dpp v168, v168, v168 row_ror:4 row_mask:0xf bank_mask:0xf
    v_add_f32_dpp v169, v169, v169 row_ror:4 row_mask:0xf bank_mask:0xf
    v_add_f32_dpp v170, v170, v170 row_ror:4 row_mask:0xf bank_mask:0xf
    v_add_f32_dpp v171, v171, v171 row_ror:4 row_mask:0xf bank_mask:0xf
    v_add_f32_dpp v164, v164, v164 row_ror:2 row_mask:0xf bank_mask:0xf
    v_add_f32_dpp v165, v165, v165 row_ror:2 row_mask:0xf bank_mask:0xf
    v_add_f32_dpp v166, v166, v166 row_ror:2 row_mask:0xf bank_mask:0xf
    v_add_f32_dpp v167, v167, v167 row_ror:2 row_mask:0xf bank_mask:0xf
    v_add_f32_dpp v168, v168, v168 row_ror:2 row_mask:0xf bank_mask:0xf
    v_add_f32_dpp v169, v169, v169 row_ror:2 row_mask:0xf bank_mask:0xf
    v_add_f32_dpp v170, v170, v170 row_ror:2 row_mask:0xf bank_mask:0xf
    v_add_f32_dpp v171, v171, v171 row_ror:2 row_mask:0xf bank_mask:0xf
    v_add_f32_dpp v164, v164, v164 row_ror:1 row_mask:0xf bank_mask:0xf
    v_add_f32_dpp v165, v165, v165 row_ror:1 row_mask:0xf bank_mask:0xf
    v_add_f32_dpp v166, v166, v166 row_ror:1 row_mask:0xf bank_mask:0xf
    v_add_f32_dpp v167, v167, v167 row_ror:1 row_mask:0xf bank_mask:0xf
    v_add_f32_dpp v168, v168, v168 row_ror:1 row_mask:0xf bank_mask:0xf
    v_add_f32_dpp v169, v169, v169 row_ror:1 row_mask:0xf bank_mask:0xf
    v_add_f32_dpp v170, v170, v170 row_ror:1 row_mask:0xf bank_mask:0xf
    v_add_f32_dpp v171, v171, v171 row_ror:1 row_mask:0xf bank_mask:0xf
    v_mul_f32 v164, s52, v164
    v_mul_f32 v165, s52, v165
    v_mul_f32 v166, s52, v166
    v_mul_f32 v167, s52, v167
    v_mul_f32 v168, s52, v168
    v_mul_f32 v169, s52, v169
    v_mul_f32 v170, s52, v170
    v_mul_f32 v171, s52, v171
    v_exp_f32 v164, v164
    v_exp_f32 v165, v165
    v_exp_f32 v166, v166
    v_exp_f32 v167, v167
    v_exp_f32 v168, v168
    v_exp_f32 v169, v169
    v_exp_f32 v170, v170
    v_exp_f32 v171, v171
    v_add_f32 v164, 1.0, v164
    v_add_f32 v165, 1.0, v165
    v_add_f32 v166, 1.0, v166
    v_add_f32 v167, 1.0, v167
    v_add_f32 v168, 1.0, v168
    v_add_f32 v169, 1.0, v169
    v_add_f32 v170, 1.0, v170
    v_add_f32 v171, 1.0, v171
    v_rcp_f32 v164, v164
    v_rcp_f32 v165, v165
    v_rcp_f32 v166, v166
    v_rcp_f32 v167, v167
    v_rcp_f32 v168, v168
    v_rcp_f32 v169, v169
    v_rcp_f32 v170, v170
    v_rcp_f32 v171, v171
    s_mov_b64 exec, 1
    buffer_store_dword v164, v3, s[20:23], s49 offen offset:32 sc1
    buffer_store_dword v165, v3, s[20:23], s49 offen offset:36 sc1
    buffer_store_dword v166, v3, s[20:23], s49 offen offset:40 sc1
    buffer_store_dword v167, v3, s[20:23], s49 offen offset:44 sc1
    buffer_store_dword v168, v3, s[20:23], s49 offen offset:48 sc1
    buffer_store_dword v169, v3, s[20:23], s49 offen offset:52 sc1
    buffer_store_dword v170, v3, s[20:23], s49 offen offset:56 sc1
    buffer_store_dword v171, v3, s[20:23], s49 offen offset:60 sc1
    s_mov_b64 exec, -1
    s_nop 1
    s_waitcnt vmcnt(24)
    v_dot2_f32_bf16 v164, v96, v160, 0
    v_dot2_f32_bf16 v165, v100, v160, 0
    v_dot2_f32_bf16 v166, v104, v160, 0
    v_dot2_f32_bf16 v167, v108, v160, 0
    v_dot2_f32_bf16 v168, v112, v160, 0
    v_dot2_f32_bf16 v169, v116, v160, 0
    v_dot2_f32_bf16 v170, v120, v160, 0
    v_dot2_f32_bf16 v171, v124, v160, 0
    v_dot2_f32_bf16 v164, v97, v161, v164
    v_dot2_f32_bf16 v165, v101, v161, v165
    v_dot2_f32_bf16 v166, v105, v161, v166
    v_dot2_f32_bf16 v167, v109, v161, v167
    v_dot2_f32_bf16 v168, v113, v161, v168
    v_dot2_f32_bf16 v169, v117, v161, v169
    v_dot2_f32_bf16 v170, v121, v161, v170
    v_dot2_f32_bf16 v171, v125, v161, v171
    v_dot2_f32_bf16 v164, v98, v162, v164
    v_dot2_f32_bf16 v165, v102, v162, v165
    v_dot2_f32_bf16 v166, v106, v162, v166
    v_dot2_f32_bf16 v167, v110, v162, v167
    v_dot2_f32_bf16 v168, v114, v162, v168
    v_dot2_f32_bf16 v169, v118, v162, v169
    v_dot2_f32_bf16 v170, v122, v162, v170
    v_dot2_f32_bf16 v171, v126, v162, v171
    v_dot2_f32_bf16 v164, v99, v163, v164
    v_dot2_f32_bf16 v165, v103, v163, v165
    v_dot2_f32_bf16 v166, v107, v163, v166
    v_dot2_f32_bf16 v167, v111, v163, v167
    v_dot2_f32_bf16 v168, v115, v163, v168
    v_dot2_f32_bf16 v169, v119, v163, v169
    v_dot2_f32_bf16 v170, v123, v163, v170
    v_dot2_f32_bf16 v171, v127, v163, v171
    s_nop 2
    v_mov_b32 v172, v164
    v_mov_b32 v173, v165
    v_mov_b32 v174, v166
    v_mov_b32 v175, v167
    v_mov_b32 v176, v168
    v_mov_b32 v177, v169
    v_mov_b32 v178, v170
    v_mov_b32 v179, v171
    v_permlane32_swap_b32 v164, v172
    v_permlane32_swap_b32 v165, v173
    v_permlane32_swap_b32 v166, v174
    v_permlane32_swap_b32 v167, v175
    v_permlane32_swap_b32 v168, v176
    v_permlane32_swap_b32 v169, v177
    v_permlane32_swap_b32 v170, v178
    v_permlane32_swap_b32 v171, v179
    s_nop 0
    v_add_f32 v164, v164, v172
    v_add_f32 v165, v165, v173
    v_add_f32 v166, v166, v174
    v_add_f32 v167, v167, v175
    v_add_f32 v168, v168, v176
    v_add_f32 v169, v169, v177
    v_add_f32 v170, v170, v178
    v_add_f32 v171, v171, v179
    v_mov_b32 v172, v164
    v_mov_b32 v173, v165
    v_mov_b32 v174, v166
    v_mov_b32 v175, v167
    v_mov_b32 v176, v168
    v_mov_b32 v177, v169
    v_mov_b32 v178, v170
    v_mov_b32 v179, v171
    v_permlane16_swap_b32 v164, v172
    v_permlane16_swap_b32 v165, v173
    v_permlane16_swap_b32 v166, v174
    v_permlane16_swap_b32 v167, v175
    v_permlane16_swap_b32 v168, v176
    v_permlane16_swap_b32 v169, v177
    v_permlane16_swap_b32 v170, v178
    v_permlane16_swap_b32 v171, v179
    s_nop 0
    v_add_f32 v164, v164, v172
    v_add_f32 v165, v165, v173
    v_add_f32 v166, v166, v174
    v_add_f32 v167, v167, v175
    v_add_f32 v168, v168, v176
    v_add_f32 v169, v169, v177
    v_add_f32 v170, v170, v178
    v_add_f32 v171, v171, v179
    v_add_f32_dpp v164, v164, v164 row_ror:8 row_mask:0xf bank_mask:0xf
    v_add_f32_dpp v165, v165, v165 row_ror:8 row_mask:0xf bank_mask:0xf
    v_add_f32_dpp v166, v166, v166 row_ror:8 row_mask:0xf bank_mask:0xf
    v_add_f32_dpp v167, v167, v167 row_ror:8 row_mask:0xf bank_mask:0xf
    v_add_f32_dpp v168, v168, v168 row_ror:8 row_mask:0xf bank_mask:0xf
    v_add_f32_dpp v169, v169, v169 row_ror:8 row_mask:0xf bank_mask:0xf
    v_add_f32_dpp v170, v170, v170 row_ror:8 row_mask:0xf bank_mask:0xf
    v_add_f32_dpp v171, v171, v171 row_ror:8 row_mask:0xf bank_mask:0xf
    v_add_f32_dpp v164, v164, v164 row_ror:4 row_mask:0xf bank_mask:0xf
    v_add_f32_dpp v165, v165, v165 row_ror:4 row_mask:0xf bank_mask:0xf
    v_add_f32_dpp v166, v166, v166 row_ror:4 row_mask:0xf bank_mask:0xf
    v_add_f32_dpp v167, v167, v167 row_ror:4 row_mask:0xf bank_mask:0xf
    v_add_f32_dpp v168, v168, v168 row_ror:4 row_mask:0xf bank_mask:0xf
    v_add_f32_dpp v169, v169, v169 row_ror:4 row_mask:0xf bank_mask:0xf
    v_add_f32_dpp v170, v170, v170 row_ror:4 row_mask:0xf bank_mask:0xf
    v_add_f32_dpp v171, v171, v171 row_ror:4 row_mask:0xf bank_mask:0xf
    v_add_f32_dpp v164, v164, v164 row_ror:2 row_mask:0xf bank_mask:0xf
    v_add_f32_dpp v165, v165, v165 row_ror:2 row_mask:0xf bank_mask:0xf
    v_add_f32_dpp v166, v166, v166 row_ror:2 row_mask:0xf bank_mask:0xf
    v_add_f32_dpp v167, v167, v167 row_ror:2 row_mask:0xf bank_mask:0xf
    v_add_f32_dpp v168, v168, v168 row_ror:2 row_mask:0xf bank_mask:0xf
    v_add_f32_dpp v169, v169, v169 row_ror:2 row_mask:0xf bank_mask:0xf
    v_add_f32_dpp v170, v170, v170 row_ror:2 row_mask:0xf bank_mask:0xf
    v_add_f32_dpp v171, v171, v171 row_ror:2 row_mask:0xf bank_mask:0xf
    v_add_f32_dpp v164, v164, v164 row_ror:1 row_mask:0xf bank_mask:0xf
    v_add_f32_dpp v165, v165, v165 row_ror:1 row_mask:0xf bank_mask:0xf
    v_add_f32_dpp v166, v166, v166 row_ror:1 row_mask:0xf bank_mask:0xf
    v_add_f32_dpp v167, v167, v167 row_ror:1 row_mask:0xf bank_mask:0xf
    v_add_f32_dpp v168, v168, v168 row_ror:1 row_mask:0xf bank_mask:0xf
    v_add_f32_dpp v169, v169, v169 row_ror:1 row_mask:0xf bank_mask:0xf
    v_add_f32_dpp v170, v170, v170 row_ror:1 row_mask:0xf bank_mask:0xf
    v_add_f32_dpp v171, v171, v171 row_ror:1 row_mask:0xf bank_mask:0xf
    v_mul_f32 v164, s52, v164
    v_mul_f32 v165, s52, v165
    v_mul_f32 v166, s52, v166
    v_mul_f32 v167, s52, v167
    v_mul_f32 v168, s52, v168
    v_mul_f32 v169, s52, v169
    v_mul_f32 v170, s52, v170
    v_mul_f32 v171, s52, v171
    v_exp_f32 v164, v164
    v_exp_f32 v165, v165
    v_exp_f32 v166, v166
    v_exp_f32 v167, v167
    v_exp_f32 v168, v168
    v_exp_f32 v169, v169
    v_exp_f32 v170, v170
    v_exp_f32 v171, v171
    v_add_f32 v164, 1.0, v164
    v_add_f32 v165, 1.0, v165
    v_add_f32 v166, 1.0, v166
    v_add_f32 v167, 1.0, v167
    v_add_f32 v168, 1.0, v168
    v_add_f32 v169, 1.0, v169
    v_add_f32 v170, 1.0, v170
    v_add_f32 v171, 1.0, v171
    v_rcp_f32 v164, v164
    v_rcp_f32 v165, v165
    v_rcp_f32 v166, v166
    v_rcp_f32 v167, v167
    v_rcp_f32 v168, v168
    v_rcp_f32 v169, v169
    v_rcp_f32 v170, v170
    v_rcp_f32 v171, v171
    s_mov_b64 exec, 1
    buffer_store_dword v164, v3, s[20:23], s49 offen offset:64 sc1
    buffer_store_dword v165, v3, s[20:23], s49 offen offset:68 sc1
    buffer_store_dword v166, v3, s[20:23], s49 offen offset:72 sc1
    buffer_store_dword v167, v3, s[20:23], s49 offen offset:76 sc1
    buffer_store_dword v168, v3, s[20:23], s49 offen offset:80 sc1
    buffer_store_dword v169, v3, s[20:23], s49 offen offset:84 sc1
    buffer_store_dword v170, v3, s[20:23], s49 offen offset:88 sc1
    buffer_store_dword v171, v3, s[20:23], s49 offen offset:92 sc1
    s_mov_b64 exec, -1
    s_nop 1
    s_waitcnt vmcnt(24)
    v_dot2_f32_bf16 v164, v128, v160, 0
    v_dot2_f32_bf16 v165, v132, v160, 0
    v_dot2_f32_bf16 v166, v136, v160, 0
    v_dot2_f32_bf16 v167, v140, v160, 0
    v_dot2_f32_bf16 v168, v144, v160, 0
    v_dot2_f32_bf16 v169, v148, v160, 0
    v_dot2_f32_bf16 v170, v152, v160, 0
    v_dot2_f32_bf16 v171, v156, v160, 0
    v_dot2_f32_bf16 v164, v129, v161, v164
    v_dot2_f32_bf16 v165, v133, v161, v165
    v_dot2_f32_bf16 v166, v137, v161, v166
    v_dot2_f32_bf16 v167, v141, v161, v167
    v_dot2_f32_bf16 v168, v145, v161, v168
    v_dot2_f32_bf16 v169, v149, v161, v169
    v_dot2_f32_bf16 v170, v153, v161, v170
    v_dot2_f32_bf16 v171, v157, v161, v171
    v_dot2_f32_bf16 v164, v130, v162, v164
    v_dot2_f32_bf16 v165, v134, v162, v165
    v_dot2_f32_bf16 v166, v138, v162, v166
    v_dot2_f32_bf16 v167, v142, v162, v167
    v_dot2_f32_bf16 v168, v146, v162, v168
    v_dot2_f32_bf16 v169, v150, v162, v169
    v_dot2_f32_bf16 v170, v154, v162, v170
    v_dot2_f32_bf16 v171, v158, v162, v171
    v_dot2_f32_bf16 v164, v131, v163, v164
    v_dot2_f32_bf16 v165, v135, v163, v165
    v_dot2_f32_bf16 v166, v139, v163, v166
    v_dot2_f32_bf16 v167, v143, v163, v167
    v_dot2_f32_bf16 v168, v147, v163, v168
    v_dot2_f32_bf16 v169, v151, v163, v169
    v_dot2_f32_bf16 v170, v155, v163, v170
    v_dot2_f32_bf16 v171, v159, v163, v171
    s_nop 2
    v_mov_b32 v172, v164
    v_mov_b32 v173, v165
    v_mov_b32 v174, v166
    v_mov_b32 v175, v167
    v_mov_b32 v176, v168
    v_mov_b32 v177, v169
    v_mov_b32 v178, v170
    v_mov_b32 v179, v171
    v_permlane32_swap_b32 v164, v172
    v_permlane32_swap_b32 v165, v173
    v_permlane32_swap_b32 v166, v174
    v_permlane32_swap_b32 v167, v175
    v_permlane32_swap_b32 v168, v176
    v_permlane32_swap_b32 v169, v177
    v_permlane32_swap_b32 v170, v178
    v_permlane32_swap_b32 v171, v179
    s_nop 0
    v_add_f32 v164, v164, v172
    v_add_f32 v165, v165, v173
    v_add_f32 v166, v166, v174
    v_add_f32 v167, v167, v175
    v_add_f32 v168, v168, v176
    v_add_f32 v169, v169, v177
    v_add_f32 v170, v170, v178
    v_add_f32 v171, v171, v179
    v_mov_b32 v172, v164
    v_mov_b32 v173, v165
    v_mov_b32 v174, v166
    v_mov_b32 v175, v167
    v_mov_b32 v176, v168
    v_mov_b32 v177, v169
    v_mov_b32 v178, v170
    v_mov_b32 v179, v171
    v_permlane16_swap_b32 v164, v172
    v_permlane16_swap_b32 v165, v173
    v_permlane16_swap_b32 v166, v174
    v_permlane16_swap_b32 v167, v175
    v_permlane16_swap_b32 v168, v176
    v_permlane16_swap_b32 v169, v177
    v_permlane16_swap_b32 v170, v178
    v_permlane16_swap_b32 v171, v179
    s_nop 0
    v_add_f32 v164, v164, v172
    v_add_f32 v165, v165, v173
    v_add_f32 v166, v166, v174
    v_add_f32 v167, v167, v175
    v_add_f32 v168, v168, v176
    v_add_f32 v169, v169, v177
    v_add_f32 v170, v170, v178
    v_add_f32 v171, v171, v179
    v_add_f32_dpp v164, v164, v164 row_ror:8 row_mask:0xf bank_mask:0xf
    v_add_f32_dpp v165, v165, v165 row_ror:8 row_mask:0xf bank_mask:0xf
    v_add_f32_dpp v166, v166, v166 row_ror:8 row_mask:0xf bank_mask:0xf
    v_add_f32_dpp v167, v167, v167 row_ror:8 row_mask:0xf bank_mask:0xf
    v_add_f32_dpp v168, v168, v168 row_ror:8 row_mask:0xf bank_mask:0xf
    v_add_f32_dpp v169, v169, v169 row_ror:8 row_mask:0xf bank_mask:0xf
    v_add_f32_dpp v170, v170, v170 row_ror:8 row_mask:0xf bank_mask:0xf
    v_add_f32_dpp v171, v171, v171 row_ror:8 row_mask:0xf bank_mask:0xf
    v_add_f32_dpp v164, v164, v164 row_ror:4 row_mask:0xf bank_mask:0xf
    v_add_f32_dpp v165, v165, v165 row_ror:4 row_mask:0xf bank_mask:0xf
    v_add_f32_dpp v166, v166, v166 row_ror:4 row_mask:0xf bank_mask:0xf
    v_add_f32_dpp v167, v167, v167 row_ror:4 row_mask:0xf bank_mask:0xf
    v_add_f32_dpp v168, v168, v168 row_ror:4 row_mask:0xf bank_mask:0xf
    v_add_f32_dpp v169, v169, v169 row_ror:4 row_mask:0xf bank_mask:0xf
    v_add_f32_dpp v170, v170, v170 row_ror:4 row_mask:0xf bank_mask:0xf
    v_add_f32_dpp v171, v171, v171 row_ror:4 row_mask:0xf bank_mask:0xf
    v_add_f32_dpp v164, v164, v164 row_ror:2 row_mask:0xf bank_mask:0xf
    v_add_f32_dpp v165, v165, v165 row_ror:2 row_mask:0xf bank_mask:0xf
    v_add_f32_dpp v166, v166, v166 row_ror:2 row_mask:0xf bank_mask:0xf
    v_add_f32_dpp v167, v167, v167 row_ror:2 row_mask:0xf bank_mask:0xf
    v_add_f32_dpp v168, v168, v168 row_ror:2 row_mask:0xf bank_mask:0xf
    v_add_f32_dpp v169, v169, v169 row_ror:2 row_mask:0xf bank_mask:0xf
    v_add_f32_dpp v170, v170, v170 row_ror:2 row_mask:0xf bank_mask:0xf
    v_add_f32_dpp v171, v171, v171 row_ror:2 row_mask:0xf bank_mask:0xf
    v_add_f32_dpp v164, v164, v164 row_ror:1 row_mask:0xf bank_mask:0xf
    v_add_f32_dpp v165, v165, v165 row_ror:1 row_mask:0xf bank_mask:0xf
    v_add_f32_dpp v166, v166, v166 row_ror:1 row_mask:0xf bank_mask:0xf
    v_add_f32_dpp v167, v167, v167 row_ror:1 row_mask:0xf bank_mask:0xf
    v_add_f32_dpp v168, v168, v168 row_ror:1 row_mask:0xf bank_mask:0xf
    v_add_f32_dpp v169, v169, v169 row_ror:1 row_mask:0xf bank_mask:0xf
    v_add_f32_dpp v170, v170, v170 row_ror:1 row_mask:0xf bank_mask:0xf
    v_add_f32_dpp v171, v171, v171 row_ror:1 row_mask:0xf bank_mask:0xf
    v_mul_f32 v164, s52, v164
    v_mul_f32 v165, s52, v165
    v_mul_f32 v166, s52, v166
    v_mul_f32 v167, s52, v167
    v_mul_f32 v168, s52, v168
    v_mul_f32 v169, s52, v169
    v_mul_f32 v170, s52, v170
    v_mul_f32 v171, s52, v171
    v_exp_f32 v164, v164
    v_exp_f32 v165, v165
    v_exp_f32 v166, v166
    v_exp_f32 v167, v167
    v_exp_f32 v168, v168
    v_exp_f32 v169, v169
    v_exp_f32 v170, v170
    v_exp_f32 v171, v171
    v_add_f32 v164, 1.0, v164
    v_add_f32 v165, 1.0, v165
    v_add_f32 v166, 1.0, v166
    v_add_f32 v167, 1.0, v167
    v_add_f32 v168, 1.0, v168
    v_add_f32 v169, 1.0, v169
    v_add_f32 v170, 1.0, v170
    v_add_f32 v171, 1.0, v171
    v_rcp_f32 v164, v164
    v_rcp_f32 v165, v165
    v_rcp_f32 v166, v166
    v_rcp_f32 v167, v167
    v_rcp_f32 v168, v168
    v_rcp_f32 v169, v169
    v_rcp_f32 v170, v170
    v_rcp_f32 v171, v171
    s_mov_b64 exec, 1
    buffer_store_dword v164, v3, s[20:23], s49 offen offset:96 sc1
    buffer_store_dword v165, v3, s[20:23], s49 offen offset:100 sc1
    buffer_store_dword v166, v3, s[20:23], s49 offen offset:104 sc1
    buffer_store_dword v167, v3, s[20:23], s49 offen offset:108 sc1
    buffer_store_dword v168, v3, s[20:23], s49 offen offset:112 sc1
    buffer_store_dword v169, v3, s[20:23], s49 offen offset:116 sc1
    buffer_store_dword v170, v3, s[20:23], s49 offen offset:120 sc1
    buffer_store_dword v171, v3, s[20:23], s49 offen offset:124 sc1
    s_mov_b64 exec, -1
    s_nop 1
B_C1:
    s_setprio 3
    s_mov_b32 s61, 0
    s_lshr_b32 s48, s57, 2
    s_lshl_b32 s48, s48, 9
    s_add_u32 s48, s48, 0xe10000
    v_lshlrev_b32 v5, 3, v1
    buffer_load_dwordx2 v[14:15], v5, s[20:23], s48 offen sc1
    s_lshl_b32 s48, s57, 16
    s_lshl_b32 s49, s58, 13
    s_add_u32 s59, s48, s49
    s_lshr_b32 s49, s24, 2
    s_lshl_b32 s49, s49, 12
    s_add_u32 s59, s59, s49
    s_add_u32 s59, s59, 0x0
    s_lshl_b32 s49, s25, 14
    s_add_u32 s49, s49, s48
    s_add_u32 s42, s49, 0x200000
    s_add_u32 s43, s49, 0x400000
    v_mov_b32 v76, 0
    v_mov_b32 v77, 0
    v_mov_b32 v78, 0
    v_mov_b32 v79, 0
    v_and_b32 v4, 31, v1
    v_cmp_eq_u32 vcc, 16, v4
    v_mov_b32 v4, 0x3f803f80
    s_nop 1
    v_cndmask_b32 v3, 0, v4, vcc
    s_nop 0
    v_accvgpr_write_b32 a0, v3
    v_accvgpr_write_b32 a1, v3
    v_accvgpr_write_b32 a2, v3
    v_accvgpr_write_b32 a3, v3
    v_accvgpr_write_b32 a4, v3
    v_accvgpr_write_b32 a5, v3
    v_accvgpr_write_b32 a6, v3
    v_accvgpr_write_b32 a7, v3
    v_accvgpr_write_b32 a8, v3
    v_accvgpr_write_b32 a9, v3
    v_accvgpr_write_b32 a10, v3
    v_accvgpr_write_b32 a11, v3
    v_accvgpr_write_b32 a12, v3
    v_accvgpr_write_b32 a13, v3
    v_accvgpr_write_b32 a14, v3
    v_accvgpr_write_b32 a15, v3
    s_nop 1
    v_mfma_f32_32x32x16_bf16 a[16:31], v[76:79], v[76:79], a[0:15]
    v_mfma_f32_32x32x16_bf16 a[32:47], v[76:79], v[76:79], a[0:15]
    v_mfma_f32_32x32x16_bf16 a[48:63], v[76:79], v[76:79], a[0:15]
    v_lshrrev_b32 v3, 5, v1
    v_lshlrev_b32 v3, 8, v3
    v_and_b32 v4, 15, v1
    v_lshlrev_b32 v4, 4, v4
    v_add_u32 v12, v3, v4
    s_mov_b32 s62, 0x0000ffff
    s_mov_b32 s63, 0x0000ffff
    s_nop 7
    s_waitcnt vmcnt(0)
S1_CKc:
    v_cmp_ne_u32 vcc, s56, v14
    v_cmp_ne_u32 s[50:51], s56, v15
    s_nop 3
    s_or_b64 vcc, vcc, s[50:51]
    s_cmp_eq_u64 vcc, 0
    s_cbranch_scc1 S1_OKc
    s_add_u32 s61, s61, 1
    s_cmp_gt_u32 s61, 400000
    s_cbranch_scc1 S1_OKc
    s_sleep 8
    s_lshr_b32 s48, s57, 2
    s_lshl_b32 s48, s48, 9
    s_add_u32 s48, s48, 0xe10000
    v_lshlrev_b32 v5, 3, v1
    buffer_load_dwordx2 v[14:15], v5, s[20:23], s48 offen sc1
    s_waitcnt vmcnt(0)
    s_branch S1_CKc
S1_OKc:
    v_lshlrev_b32 v3, 2, v1
    s_lshl_b32 s48, s57, 8
    s_add_u32 s49, s48, 0xe02000
    buffer_load_dword v14, v3, s[20:23], s49 offen sc1
    v_and_b32 v4, 7, v1
    v_lshlrev_b32 v4, 2, v4
    s_lshl_b32 s50, s58, 5
    s_add_u32 s49, s48, s50
    s_add_u32 s49, s49, 0xe00000
    buffer_load_dword v15, v4, s[20:23], s49 offen sc1
    buffer_load_dwordx4 v[72:75], v2, s[20:23], s59 offen sc1
    s_mov_b32 s52, 0xbdd2d3e8
    s_mov_b32 s53, 0xbdd2d3e8
    s_mov_b32 s54, 1.0
    s_mov_b32 s55, 1.0
    v_mov_b32 v40, 0xc0135761
    v_mov_b32 v41, 0xc0135761
    s_lshl_b32 s48, s32, 2
    s_add_u32 s48, s48, s25
    s_mul_i32 s48, s48, 86
    s_mul_i32 s49, s33, 6
    s_add_u32 s48, s48, s49
    s_lshl_b32 s48, s48, 10
    s_add_u32 s48, s48, 0x800000
    s_cmp_eq_u32 s33, 15
    s_cselect_b32 s48, 0x40000000, s48
    v_pk_mul_f32 v[32:33], v[96:97], v[96:97]
    v_pk_mul_f32 v[34:35], v[98:99], v[98:99]
    v_pk_mul_f32 v[36:37], v[100:101], v[100:101]
    v_pk_mul_f32 v[38:39], v[102:103], v[102:103]
    v_pk_fma_f32 v[32:33], v[32:33], s[52:53], v[40:41]
    v_pk_fma_f32 v[34:35], v[34:35], s[52:53], v[40:41]
    v_pk_fma_f32 v[36:37], v[36:37], s[52:53], v[40:41]
    v_pk_fma_f32 v[38:39], v[38:39], s[52:53], v[40:41]
    buffer_load_dwordx4 v[80:83], v2, s[20:23], s42 offen offset:0 sc1
    v_pk_mul_f32 v[32:33], v[32:33], v[96:97]
    v_pk_mul_f32 v[34:35], v[34:35], v[98:99]
    v_pk_mul_f32 v[36:37], v[36:37], v[100:101]
    v_pk_mul_f32 v[38:39], v[38:39], v[102:103]
    v_exp_f32 v32, v32
    v_exp_f32 v33, v33
    v_exp_f32 v34, v34
    v_exp_f32 v35, v35
    v_exp_f32 v36, v36
    v_exp_f32 v37, v37
    v_exp_f32 v38, v38
    v_exp_f32 v39, v39
    buffer_load_dwordx4 v[84:87], v2, s[20:23], s42 offen offset:1024 sc1
    v_pk_add_f32 v[32:33], v[32:33], s[54:55]
    v_pk_add_f32 v[34:35], v[34:35], s[54:55]
    v_pk_add_f32 v[36:37], v[36:37], s[54:55]
    v_pk_add_f32 v[38:39], v[38:39], s[54:55]
    v_rcp_f32 v32, v32
    v_rcp_f32 v33, v33
    v_rcp_f32 v34, v34
    v_rcp_f32 v35, v35
    v_rcp_f32 v36, v36
    v_rcp_f32 v37, v37
    v_rcp_f32 v38, v38
    v_rcp_f32 v39, v39
    buffer_load_dwordx4 v[88:91], v2, s[20:23], s42 offen offset:2048 sc1
    v_pk_mul_f32 v[96:97], v[96:97], v[144:145]
    v_pk_mul_f32 v[98:99], v[98:99], v[146:147]
    v_pk_mul_f32 v[100:101], v[100:101], v[148:149]
    v_pk_mul_f32 v[102:103], v[102:103], v[150:151]
    v_pk_mul_f32 v[32:33], v[32:33], v[96:97]
    v_pk_mul_f32 v[34:35], v[34:35], v[98:99]
    v_pk_mul_f32 v[36:37], v[36:37], v[100:101]
    v_pk_mul_f32 v[38:39], v[38:39], v[102:103]
    v_cvt_pk_bf16_f32 v48, v32, v33
    v_cvt_pk_bf16_f32 v49, v34, v35
    v_cvt_pk_bf16_f32 v50, v36, v37
    v_cvt_pk_bf16_f32 v51, v38, v39
    buffer_store_dwordx4 v[48:51], v2, s[20:23], s48 offen offset:0 sc1
    buffer_load_dwordx4 v[92:95], v2, s[20:23], s42 offen offset:3072 sc1
    s_add_u32 s42, s42, 4096
    v_pk_mul_f32 v[32:33], v[104:105], v[104:105]
    v_pk_mul_f32 v[34:35], v[106:107], v[106:107]
    v_pk_mul_f32 v[36:37], v[108:109], v[108:109]
    v_pk_mul_f32 v[38:39], v[110:111], v[110:111]
    v_pk_fma_f32 v[32:33], v[32:33], s[52:53], v[40:41]
    v_pk_fma_f32 v[34:35], v[34:35], s[52:53], v[40:41]
    v_pk_fma_f32 v[36:37], v[36:37], s[52:53], v[40:41]
    v_pk_fma_f32 v[38:39], v[38:39], s[52:53], v[40:41]
    s_mov_b64 exec, s[62:63]
    buffer_load_dwordx4 a[0:3], v12, s[20:23], s43 offen offset:0 sc1
    buffer_load_dwordx4 a[4:7], v12, s[20:23], s43 offen offset:512 sc1
    s_mov_b64 exec, -1
    v_pk_mul_f32 v[32:33], v[32:33], v[104:105]
    v_pk_mul_f32 v[34:35], v[34:35], v[106:107]
    v_pk_mul_f32 v[36:37], v[36:37], v[108:109]
    v_pk_mul_f32 v[38:39], v[38:39], v[110:111]
    v_exp_f32 v32, v32
    v_exp_f32 v33, v33
    v_exp_f32 v34, v34
    v_exp_f32 v35, v35
    v_exp_f32 v36, v36
    v_exp_f32 v37, v37
    v_exp_f32 v38, v38
    v_exp_f32 v39, v39
    s_mov_b64 exec, s[62:63]
    buffer_load_dwordx4 a[8:11], v12, s[20:23], s43 offen offset:1024 sc1
    buffer_load_dwordx4 a[12:15], v12, s[20:23], s43 offen offset:1536 sc1
    s_mov_b64 exec, -1
    v_pk_add_f32 v[32:33], v[32:33], s[54:55]
    v_pk_add_f32 v[34:35], v[34:35], s[54:55]
    v_pk_add_f32 v[36:37], v[36:37], s[54:55]
    v_pk_add_f32 v[38:39], v[38:39], s[54:55]
    v_rcp_f32 v32, v32
    v_rcp_f32 v33, v33
    v_rcp_f32 v34, v34
    v_rcp_f32 v35, v35
    v_rcp_f32 v36, v36
    v_rcp_f32 v37, v37
    v_rcp_f32 v38, v38
    v_rcp_f32 v39, v39
    s_mov_b64 exec, s[62:63]
    buffer_load_dwordx4 a[16:19], v12, s[20:23], s43 offen offset:2048 sc1
    buffer_load_dwordx4 a[20:23], v12, s[20:23], s43 offen offset:2560 sc1
    s_mov_b64 exec, -1
    v_pk_mul_f32 v[104:105], v[104:105], v[152:153]
    v_pk_mul_f32 v[106:107], v[106:107], v[154:155]
    v_pk_mul_f32 v[108:109], v[108:109], v[156:157]
    v_pk_mul_f32 v[110:111], v[110:111], v[158:159]
    v_pk_mul_f32 v[32:33], v[32:33], v[104:105]
    v_pk_mul_f32 v[34:35], v[34:35], v[106:107]
    v_pk_mul_f32 v[36:37], v[36:37], v[108:109]
    v_pk_mul_f32 v[38:39], v[38:39], v[110:111]
    v_cvt_pk_bf16_f32 v52, v32, v33
    v_cvt_pk_bf16_f32 v53, v34, v35
    v_cvt_pk_bf16_f32 v54, v36, v37
    v_cvt_pk_bf16_f32 v55, v38, v39
    buffer_store_dwordx4 v[52:55], v2, s[20:23], s48 offen offset:1024 sc1
    s_mov_b64 exec, s[62:63]
    buffer_load_dwordx4 a[24:27], v12, s[20:23], s43 offen offset:3072 sc1
    buffer_load_dwordx4 a[28:31], v12, s[20:23], s43 offen offset:3584 sc1
    s_mov_b64 exec, -1
    s_add_u32 s43, s43, 4096
    s_add_u32 s48, s48, 2048
    s_cmp_eq_u32 s33, 14
    s_cselect_b32 s48, 0x40000000, s48
    v_pk_mul_f32 v[32:33], v[112:113], v[112:113]
    v_pk_mul_f32 v[34:35], v[114:115], v[114:115]
    v_pk_mul_f32 v[36:37], v[116:117], v[116:117]
    v_pk_mul_f32 v[38:39], v[118:119], v[118:119]
    v_pk_fma_f32 v[32:33], v[32:33], s[52:53], v[40:41]
    v_pk_fma_f32 v[34:35], v[34:35], s[52:53], v[40:41]
    v_pk_fma_f32 v[36:37], v[36:37], s[52:53], v[40:41]
    v_pk_fma_f32 v[38:39], v[38:39], s[52:53], v[40:41]
    v_pk_mul_f32 v[32:33], v[32:33], v[112:113]
    v_pk_mul_f32 v[34:35], v[34:35], v[114:115]
    v_pk_mul_f32 v[36:37], v[36:37], v[116:117]
    v_pk_mul_f32 v[38:39], v[38:39], v[118:119]
    v_exp_f32 v32, v32
    v_exp_f32 v33, v33
    v_exp_f32 v34, v34
    v_exp_f32 v35, v35
    v_exp_f32 v36, v36
    v_exp_f32 v37, v37
    v_exp_f32 v38, v38
    v_exp_f32 v39, v39
    s_mov_b64 exec, s[62:63]
    buffer_load_dwordx4 a[32:35], v12, s[20:23], s43 offen offset:0 sc1
    buffer_load_dwordx4 a[36:39], v12, s[20:23], s43 offen offset:512 sc1
    s_mov_b64 exec, -1
    v_pk_add_f32 v[32:33], v[32:33], s[54:55]
    v_pk_add_f32 v[34:35], v[34:35], s[54:55]
    v_pk_add_f32 v[36:37], v[36:37], s[54:55]
    v_pk_add_f32 v[38:39], v[38:39], s[54:55]
    v_rcp_f32 v32, v32
    v_rcp_f32 v33, v33
    v_rcp_f32 v34, v34
    v_rcp_f32 v35, v35
    v_rcp_f32 v36, v36
    v_rcp_f32 v37, v37
    v_rcp_f32 v38, v38
    v_rcp_f32 v39, v39
    v_pk_mul_f32 v[112:113], v[112:113], v[160:161]
    v_pk_mul_f32 v[114:115], v[114:115], v[162:163]
    v_pk_mul_f32 v[116:117], v[116:117], v[164:165]
    v_pk_mul_f32 v[118:119], v[118:119], v[166:167]
    v_pk_mul_f32 v[32:33], v[32:33], v[112:113]
    v_pk_mul_f32 v[34:35], v[34:35], v[114:115]
    v_pk_mul_f32 v[36:37], v[36:37], v[116:117]
    v_pk_mul_f32 v[38:39], v[38:39], v[118:119]
    v_cvt_pk_bf16_f32 v56, v32, v33
    v_cvt_pk_bf16_f32 v57, v34, v35
    v_cvt_pk_bf16_f32 v58, v36, v37
    v_cvt_pk_bf16_f32 v59, v38, v39
    buffer_store_dwordx4 v[56:59], v2, s[20:23], s48 offen offset:0 sc1
    s_mov_b64 exec, s[62:63]
    buffer_load_dwordx4 a[40:43], v12, s[20:23], s43 offen offset:1024 sc1
    buffer_load_dwordx4 a[44:47], v12, s[20:23], s43 offen offset:1536 sc1
    s_mov_b64 exec, -1
    v_pk_mul_f32 v[32:33], v[120:121], v[120:121]
    v_pk_mul_f32 v[34:35], v[122:123], v[122:123]
    v_pk_mul_f32 v[36:37], v[124:125], v[124:125]
    v_pk_mul_f32 v[38:39], v[126:127], v[126:127]
    v_pk_fma_f32 v[32:33], v[32:33], s[52:53], v[40:41]
    v_pk_fma_f32 v[34:35], v[34:35], s[52:53], v[40:41]
    v_pk_fma_f32 v[36:37], v[36:37], s[52:53], v[40:41]
    v_pk_fma_f32 v[38:39], v[38:39], s[52:53], v[40:41]
    v_pk_mul_f32 v[32:33], v[32:33], v[120:121]
    v_pk_mul_f32 v[34:35], v[34:35], v[122:123]
    v_pk_mul_f32 v[36:37], v[36:37], v[124:125]
    v_pk_mul_f32 v[38:39], v[38:39], v[126:127]
    v_exp_f32 v32, v32
    v_exp_f32 v33, v33
    v_exp_f32 v34, v34
    v_exp_f32 v35, v35
    v_exp_f32 v36, v36
    v_exp_f32 v37, v37
    v_exp_f32 v38, v38
    v_exp_f32 v39, v39
    s_mov_b64 exec, s[62:63]
    buffer_load_dwordx4 a[48:51], v12, s[20:23], s43 offen offset:2048 sc1
    buffer_load_dwordx4 a[52:55], v12, s[20:23], s43 offen offset:2560 sc1
    s_mov_b64 exec, -1
    v_pk_add_f32 v[32:33], v[32:33], s[54:55]
    v_pk_add_f32 v[34:35], v[34:35], s[54:55]
    v_pk_add_f32 v[36:37], v[36:37], s[54:55]
    v_pk_add_f32 v[38:39], v[38:39], s[54:55]
    v_rcp_f32 v32, v32
    v_rcp_f32 v33, v33
    v_rcp_f32 v34, v34
    v_rcp_f32 v35, v35
    v_rcp_f32 v36, v36
    v_rcp_f32 v37, v37
    v_rcp_f32 v38, v38
    v_rcp_f32 v39, v39
    v_pk_mul_f32 v[120:121], v[120:121], v[168:169]
    v_pk_mul_f32 v[122:123], v[122:123], v[170:171]
    v_pk_mul_f32 v[124:125], v[124:125], v[172:173]
    v_pk_mul_f32 v[126:127], v[126:127], v[174:175]
    v_pk_mul_f32 v[32:33], v[32:33], v[120:121]
    v_pk_mul_f32 v[34:35], v[34:35], v[122:123]
    v_pk_mul_f32 v[36:37], v[36:37], v[124:125]
    v_pk_mul_f32 v[38:39], v[38:39], v[126:127]
    v_cvt_pk_bf16_f32 v60, v32, v33
    v_cvt_pk_bf16_f32 v61, v34, v35
    v_cvt_pk_bf16_f32 v62, v36, v37
    v_cvt_pk_bf16_f32 v63, v38, v39
    buffer_store_dwordx4 v[60:63], v2, s[20:23], s48 offen offset:1024 sc1
    s_mov_b64 exec, s[62:63]
    buffer_load_dwordx4 a[56:59], v12, s[20:23], s43 offen offset:3072 sc1
    buffer_load_dwordx4 a[60:63], v12, s[20:23], s43 offen offset:3584 sc1
    s_mov_b64 exec, -1
    s_add_u32 s48, s48, 2048
    v_pk_mul_f32 v[32:33], v[128:129], v[128:129]
    v_pk_mul_f32 v[34:35], v[130:131], v[130:131]
    v_pk_mul_f32 v[36:37], v[132:133], v[132:133]
    v_pk_mul_f32 v[38:39], v[134:135], v[134:135]
    v_pk_fma_f32 v[32:33], v[32:33], s[52:53], v[40:41]
    v_pk_fma_f32 v[34:35], v[34:35], s[52:53], v[40:41]
    v_pk_fma_f32 v[36:37], v[36:37], s[52:53], v[40:41]
    v_pk_fma_f32 v[38:39], v[38:39], s[52:53], v[40:41]
    v_pk_mul_f32 v[32:33], v[32:33], v[128:129]
    v_pk_mul_f32 v[34:35], v[34:35], v[130:131]
    v_pk_mul_f32 v[36:37], v[36:37], v[132:133]
    v_pk_mul_f32 v[38:39], v[38:39], v[134:135]
    v_exp_f32 v32, v32
    v_exp_f32 v33, v33
    v_exp_f32 v34, v34
    v_exp_f32 v35, v35
    v_exp_f32 v36, v36
    v_exp_f32 v37, v37
    v_exp_f32 v38, v38
    v_exp_f32 v39, v39
    buffer_load_dwordx4 v[96:99], v2, s[20:23], s42 offen offset:0 sc1
    v_pk_add_f32 v[32:33], v[32:33], s[54:55]
    v_pk_add_f32 v[34:35], v[34:35], s[54:55]
    v_pk_add_f32 v[36:37], v[36:37], s[54:55]
    v_pk_add_f32 v[38:39], v[38:39], s[54:55]
    v_rcp_f32 v32, v32
    v_rcp_f32 v33, v33
    v_rcp_f32 v34, v34
    v_rcp_f32 v35, v35
    v_rcp_f32 v36, v36
    v_rcp_f32 v37, v37
    v_rcp_f32 v38, v38
    v_rcp_f32 v39, v39
    v_pk_mul_f32 v[128:129], v[128:129], v[176:177]
    v_pk_mul_f32 v[130:131], v[130:131], v[178:179]
    v_pk_mul_f32 v[132:133], v[132:133], v[180:181]
    v_pk_mul_f32 v[134:135], v[134:135], v[182:183]
    v_pk_mul_f32 v[32:33], v[32:33], v[128:129]
    v_pk_mul_f32 v[34:35], v[34:35], v[130:131]
    v_pk_mul_f32 v[36:37], v[36:37], v[132:133]
    v_pk_mul_f32 v[38:39], v[38:39], v[134:135]
    v_cvt_pk_bf16_f32 v48, v32, v33
    v_cvt_pk_bf16_f32 v49, v34, v35
    v_cvt_pk_bf16_f32 v50, v36, v37
    v_cvt_pk_bf16_f32 v51, v38, v39
    buffer_store_dwordx4 v[48:51], v2, s[20:23], s48 offen offset:0 sc1
    buffer_load_dwordx4 v[100:103], v2, s[20:23], s42 offen offset:1024 sc1
    v_pk_mul_f32 v[32:33], v[136:137], v[136:137]
    v_pk_mul_f32 v[34:35], v[138:139], v[138:139]
    v_pk_mul_f32 v[36:37], v[140:141], v[140:141]
    v_pk_mul_f32 v[38:39], v[142:143], v[142:143]
    v_pk_fma_f32 v[32:33], v[32:33], s[52:53], v[40:41]
    v_pk_fma_f32 v[34:35], v[34:35], s[52:53], v[40:41]
    v_pk_fma_f32 v[36:37], v[36:37], s[52:53], v[40:41]
    v_pk_fma_f32 v[38:39], v[38:39], s[52:53], v[40:41]
    v_pk_mul_f32 v[32:33], v[32:33], v[136:137]
    v_pk_mul_f32 v[34:35], v[34:35], v[138:139]
    v_pk_mul_f32 v[36:37], v[36:37], v[140:141]
    v_pk_mul_f32 v[38:39], v[38:39], v[142:143]
    v_exp_f32 v32, v32
    v_exp_f32 v33, v33
    v_exp_f32 v34, v34
    v_exp_f32 v35, v35
    v_exp_f32 v36, v36
    v_exp_f32 v37, v37
    v_exp_f32 v38, v38
    v_exp_f32 v39, v39
    buffer_load_dwordx4 v[104:107], v2, s[20:23], s42 offen offset:2048 sc1
    v_pk_add_f32 v[32:33], v[32:33], s[54:55]
    v_pk_add_f32 v[34:35], v[34:35], s[54:55]
    v_pk_add_f32 v[36:37], v[36:37], s[54:55]
    v_pk_add_f32 v[38:39], v[38:39], s[54:55]
    v_rcp_f32 v32, v32
    v_rcp_f32 v33, v33
    v_rcp_f32 v34, v34
    v_rcp_f32 v35, v35
    v_rcp_f32 v36, v36
    v_rcp_f32 v37, v37
    v_rcp_f32 v38, v38
    v_rcp_f32 v39, v39
    v_pk_mul_f32 v[136:137], v[136:137], v[184:185]
    v_pk_mul_f32 v[138:139], v[138:139], v[186:187]
    v_pk_mul_f32 v[140:141], v[140:141], v[188:189]
    v_pk_mul_f32 v[142:143], v[142:143], v[190:191]
    v_pk_mul_f32 v[32:33], v[32:33], v[136:137]
    v_pk_mul_f32 v[34:35], v[34:35], v[138:139]
    v_pk_mul_f32 v[36:37], v[36:37], v[140:141]
    v_pk_mul_f32 v[38:39], v[38:39], v[142:143]
    v_cvt_pk_bf16_f32 v52, v32, v33
    v_cvt_pk_bf16_f32 v53, v34, v35
    v_cvt_pk_bf16_f32 v54, v36, v37
    v_cvt_pk_bf16_f32 v55, v38, v39
    buffer_store_dwordx4 v[52:55], v2, s[20:23], s48 offen offset:1024 sc1
    buffer_load_dwordx4 v[108:111], v2, s[20:23], s42 offen offset:3072 sc1
    s_add_u32 s48, s48, 2048
    s_waitcnt vmcnt(0)
    s_lshl_b32 s48, s32, 1
    s_lshr_b32 s49, s25, 1
    s_add_u32 s48, s48, s49
    s_lshl_b32 s48, s48, 7
    s_lshl_b32 s49, s33, 1
    s_and_b32 s50, s25, 1
    s_add_u32 s49, s49, s50
    s_lshl_b32 s49, s49, 2
    s_add_u32 s48, s48, s49
    s_add_u32 s48, s48, 0xe11000
    v_mov_b32 v3, s56
    v_mov_b32 v4, 0
    s_mov_b64 exec, 1
    buffer_store_dword v3, v4, s[20:23], s48 offen sc1
    s_mov_b64 exec, -1
    v_mov_b32 v3, v14
    v_mov_b32 v4, v15
    s_nop 0
    v_permlane32_swap_b32 v14, v3
    v_permlane32_swap_b32 v15, v4
    s_nop 0
    v_max_f32 v14, v14, v3
    v_max_f32 v15, v15, v4
    v_mov_b32 v3, v14
    v_mov_b32 v4, v15
    s_nop 0
    v_permlane16_swap_b32 v14, v3
    v_permlane16_swap_b32 v15, v4
    s_nop 0
    v_max_f32 v14, v14, v3
    v_max_f32 v15, v15, v4
    s_nop 0
    v_max_f32_dpp v14, v14, v14 row_ror:8 row_mask:0xf bank_mask:0xf
    v_max_f32_dpp v15, v15, v15 row_ror:8 row_mask:0xf bank_mask:0xf
    s_nop 0
    v_max_f32_dpp v14, v14, v14 row_ror:4 row_mask:0xf bank_mask:0xf
    v_max_f32_dpp v15, v15, v15 row_ror:4 row_mask:0xf bank_mask:0xf
    s_nop 0
    v_max_f32_dpp v14, v14, v14 row_ror:2 row_mask:0xf bank_mask:0xf
    v_max_f32_dpp v15, v15, v15 row_ror:2 row_mask:0xf bank_mask:0xf
    s_nop 0
    v_max_f32_dpp v14, v14, v14 row_ror:1 row_mask:0xf bank_mask:0xf
    v_max_f32_dpp v15, v15, v15 row_ror:1 row_mask:0xf bank_mask:0xf
    v_mul_f32 v14, v14, v15
    v_sqrt_f32 v14, v14
    v_mov_b32 v15, 0x42400000
    v_cmp_nle_f32 vcc, v14, v15
    v_sub_f32 v14, 0, v14
    s_nop 1
    s_cmp_lg_u64 vcc, 0
    s_cselect_b32 s60, 1, 0
    v_mov_b32 v48, v14
    v_mov_b32 v49, v14
    v_mov_b32 v50, v14
    v_mov_b32 v51, v14
    v_mov_b32 v52, v14
    v_mov_b32 v53, v14
    v_mov_b32 v54, v14
    v_mov_b32 v55, v14
    v_mov_b32 v56, v14
    v_mov_b32 v57, v14
    v_mov_b32 v58, v14
    v_mov_b32 v59, v14
    v_mov_b32 v60, v14
    v_mov_b32 v61, v14
    v_mov_b32 v62, v14
    v_mov_b32 v63, v14
    s_setprio 1
K_ATT:
    s_cmp_eq_u32 s60, 0
    s_cbranch_scc1 SLOWP_END
    v_and_b32 v38, 31, v1
    v_lshlrev_b32 v38, 2, v38
    s_lshr_b32 s48, s24, 2
    s_lshl_b32 s48, s48, 9
    s_add_u32 s48, s48, 139264
    v_add_u32 v13, s48, v38
    s_lshl_b32 s48, s25, 10
    v_add_u32 v38, s48, v13
    v_mov_b32 v32, 0xff800000
    v_mov_b32 v33, 0xff800000
    v_mov_b32 v34, 0xff800000
    v_mov_b32 v35, 0xff800000
    s_sub_u32 s51, s42, 4096
    s_mov_b32 s39, 0
SLOWP_H:
    s_add_u32 s50, s51, 0
    buffer_load_dwordx4 v[80:83], v2, s[20:23], s50 offen sc1
    s_add_u32 s50, s51, 1024
    buffer_load_dwordx4 v[84:87], v2, s[20:23], s50 offen sc1
    s_add_u32 s50, s51, 2048
    buffer_load_dwordx4 v[88:91], v2, s[20:23], s50 offen sc1
    s_add_u32 s50, s51, 3072
    buffer_load_dwordx4 v[92:95], v2, s[20:23], s50 offen sc1
    s_add_u32 s50, s51, 4096
    buffer_load_dwordx4 v[96:99], v2, s[20:23], s50 offen sc1
    s_add_u32 s50, s51, 5120
    buffer_load_dwordx4 v[100:103], v2, s[20:23], s50 offen sc1
    s_add_u32 s50, s51, 6144
    buffer_load_dwordx4 v[104:107], v2, s[20:23], s50 offen sc1
    s_add_u32 s50, s51, 7168
    buffer_load_dwordx4 v[108:111], v2, s[20:23], s50 offen sc1
    s_add_u32 s50, s59, 0
    buffer_load_dwordx4 v[76:79], v2, s[20:23], s50 offen sc1
    s_waitcnt vmcnt(0)
    v_mfma_f32_32x32x16_bf16 v[16:31], v[80:83], v[76:79], 0
    s_nop 15
    v_max3_f32 v32, v32, v16, v17
    v_max3_f32 v32, v32, v18, v19
    v_max3_f32 v32, v32, v20, v21
    v_max3_f32 v32, v32, v22, v23
    v_max3_f32 v32, v32, v24, v25
    v_max3_f32 v32, v32, v26, v27
    v_max3_f32 v32, v32, v28, v29
    v_max3_f32 v32, v32, v30, v31
    s_nop 1
    v_mfma_f32_32x32x16_bf16 v[16:31], v[84:87], v[76:79], 0
    s_nop 15
    v_max3_f32 v32, v32, v16, v17
    v_max3_f32 v32, v32, v18, v19
    v_max3_f32 v32, v32, v20, v21
    v_max3_f32 v32, v32, v22, v23
    v_max3_f32 v32, v32, v24, v25
    v_max3_f32 v32, v32, v26, v27
    v_max3_f32 v32, v32, v28, v29
    v_max3_f32 v32, v32, v30, v31
    s_nop 1
    v_mfma_f32_32x32x16_bf16 v[16:31], v[88:91], v[76:79], 0
    s_nop 15
    v_max3_f32 v32, v32, v16, v17
    v_max3_f32 v32, v32, v18, v19
    v_max3_f32 v32, v32, v20, v21
    v_max3_f32 v32, v32, v22, v23
    v_max3_f32 v32, v32, v24, v25
    v_max3_f32 v32, v32, v26, v27
    v_max3_f32 v32, v32, v28, v29
    v_max3_f32 v32, v32, v30, v31
    s_nop 1
    v_mfma_f32_32x32x16_bf16 v[16:31], v[92:95], v[76:79], 0
    s_nop 15
    v_max3_f32 v32, v32, v16, v17
    v_max3_f32 v32, v32, v18, v19
    v_max3_f32 v32, v32, v20, v21
    v_max3_f32 v32, v32, v22, v23
    v_max3_f32 v32, v32, v24, v25
    v_max3_f32 v32, v32, v26, v27
    v_max3_f32 v32, v32, v28, v29
    v_max3_f32 v32, v32, v30, v31
    s_nop 1
    v_mfma_f32_32x32x16_bf16 v[16:31], v[96:99], v[76:79], 0
    s_nop 15
    v_max3_f32 v32, v32, v16, v17
    v_max3_f32 v32, v32, v18, v19
    v_max3_f32 v32, v32, v20, v21
    v_max3_f32 v32, v32, v22, v23
    v_max3_f32 v32, v32, v24, v25
    v_max3_f32 v32, v32, v26, v27
    v_max3_f32 v32, v32, v28, v29
    v_max3_f32 v32, v32, v30, v31
    s_nop 1
    v_mfma_f32_32x32x16_bf16 v[16:31], v[100:103], v[76:79], 0
    s_nop 15
    v_max3_f32 v32, v32, v16, v17
    v_max3_f32 v32, v32, v18, v19
    v_max3_f32 v32, v32, v20, v21
    v_max3_f32 v32, v32, v22, v23
    v_max3_f32 v32, v32, v24, v25
    v_max3_f32 v32, v32, v26, v27
    v_max3_f32 v32, v32, v28, v29
    v_max3_f32 v32, v32, v30, v31
    s_nop 1
    v_mfma_f32_32x32x16_bf16 v[16:31], v[104:107], v[76:79], 0
    s_nop 15
    v_max3_f32 v32, v32, v16, v17
    v_max3_f32 v32, v32, v18, v19
    v_max3_f32 v32, v32, v20, v21
    v_max3_f32 v32, v32, v22, v23
    v_max3_f32 v32, v32, v24, v25
    v_max3_f32 v32, v32, v26, v27
    v_max3_f32 v32, v32, v28, v29
    v_max3_f32 v32, v32, v30, v31
    s_nop 1
    v_mfma_f32_32x32x16_bf16 v[16:31], v[108:111], v[76:79], 0
    s_nop 15
    v_max3_f32 v32, v32, v16, v17
    v_max3_f32 v32, v32, v18, v19
    v_max3_f32 v32, v32, v20, v21
    v_max3_f32 v32, v32, v22, v23
    v_max3_f32 v32, v32, v24, v25
    v_max3_f32 v32, v32, v26, v27
    v_max3_f32 v32, v32, v28, v29
    v_max3_f32 v32, v32, v30, v31
    s_nop 1
    s_add_u32 s50, s59, 1024
    buffer_load_dwordx4 v[76:79], v2, s[20:23], s50 offen sc1
    s_waitcnt vmcnt(0)
    v_mfma_f32_32x32x16_bf16 v[16:31], v[80:83], v[76:79], 0
    s_nop 15
    v_max3_f32 v33, v33, v16, v17
    v_max3_f32 v33, v33, v18, v19
    v_max3_f32 v33, v33, v20, v21
    v_max3_f32 v33, v33, v22, v23
    v_max3_f32 v33, v33, v24, v25
    v_max3_f32 v33, v33, v26, v27
    v_max3_f32 v33, v33, v28, v29
    v_max3_f32 v33, v33, v30, v31
    s_nop 1
    v_mfma_f32_32x32x16_bf16 v[16:31], v[84:87], v[76:79], 0
    s_nop 15
    v_max3_f32 v33, v33, v16, v17
    v_max3_f32 v33, v33, v18, v19
    v_max3_f32 v33, v33, v20, v21
    v_max3_f32 v33, v33, v22, v23
    v_max3_f32 v33, v33, v24, v25
    v_max3_f32 v33, v33, v26, v27
    v_max3_f32 v33, v33, v28, v29
    v_max3_f32 v33, v33, v30, v31
    s_nop 1
    v_mfma_f32_32x32x16_bf16 v[16:31], v[88:91], v[76:79], 0
    s_nop 15
    v_max3_f32 v33, v33, v16, v17
    v_max3_f32 v33, v33, v18, v19
    v_max3_f32 v33, v33, v20, v21
    v_max3_f32 v33, v33, v22, v23
    v_max3_f32 v33, v33, v24, v25
    v_max3_f32 v33, v33, v26, v27
    v_max3_f32 v33, v33, v28, v29
    v_max3_f32 v33, v33, v30, v31
    s_nop 1
    v_mfma_f32_32x32x16_bf16 v[16:31], v[92:95], v[76:79], 0
    s_nop 15
    v_max3_f32 v33, v33, v16, v17
    v_max3_f32 v33, v33, v18, v19
    v_max3_f32 v33, v33, v20, v21
    v_max3_f32 v33, v33, v22, v23
    v_max3_f32 v33, v33, v24, v25
    v_max3_f32 v33, v33, v26, v27
    v_max3_f32 v33, v33, v28, v29
    v_max3_f32 v33, v33, v30, v31
    s_nop 1
    v_mfma_f32_32x32x16_bf16 v[16:31], v[96:99], v[76:79], 0
    s_nop 15
    v_max3_f32 v33, v33, v16, v17
    v_max3_f32 v33, v33, v18, v19
    v_max3_f32 v33, v33, v20, v21
    v_max3_f32 v33, v33, v22, v23
    v_max3_f32 v33, v33, v24, v25
    v_max3_f32 v33, v33, v26, v27
    v_max3_f32 v33, v33, v28, v29
    v_max3_f32 v33, v33, v30, v31
    s_nop 1
    v_mfma_f32_32x32x16_bf16 v[16:31], v[100:103], v[76:79], 0
    s_nop 15
    v_max3_f32 v33, v33, v16, v17
    v_max3_f32 v33, v33, v18, v19
    v_max3_f32 v33, v33, v20, v21
    v_max3_f32 v33, v33, v22, v23
    v_max3_f32 v33, v33, v24, v25
    v_max3_f32 v33, v33, v26, v27
    v_max3_f32 v33, v33, v28, v29
    v_max3_f32 v33, v33, v30, v31
    s_nop 1
    v_mfma_f32_32x32x16_bf16 v[16:31], v[104:107], v[76:79], 0
    s_nop 15
    v_max3_f32 v33, v33, v16, v17
    v_max3_f32 v33, v33, v18, v19
    v_max3_f32 v33, v33, v20, v21
    v_max3_f32 v33, v33, v22, v23
    v_max3_f32 v33, v33, v24, v25
    v_max3_f32 v33, v33, v26, v27
    v_max3_f32 v33, v33, v28, v29
    v_max3_f32 v33, v33, v30, v31
    s_nop 1
    v_mfma_f32_32x32x16_bf16 v[16:31], v[108:111], v[76:79], 0
    s_nop 15
    v_max3_f32 v33, v33, v16, v17
    v_max3_f32 v33, v33, v18, v19
    v_max3_f32 v33, v33, v20, v21
    v_max3_f32 v33, v33, v22, v23
    v_max3_f32 v33, v33, v24, v25
    v_max3_f32 v33, v33, v26, v27
    v_max3_f32 v33, v33, v28, v29
    v_max3_f32 v33, v33, v30, v31
    s_nop 1
    s_add_u32 s50, s59, 2048
    buffer_load_dwordx4 v[76:79], v2, s[20:23], s50 offen sc1
    s_waitcnt vmcnt(0)
    v_mfma_f32_32x32x16_bf16 v[16:31], v[80:83], v[76:79], 0
    s_nop 15
    v_max3_f32 v34, v34, v16, v17
    v_max3_f32 v34, v34, v18, v19
    v_max3_f32 v34, v34, v20, v21
    v_max3_f32 v34, v34, v22, v23
    v_max3_f32 v34, v34, v24, v25
    v_max3_f32 v34, v34, v26, v27
    v_max3_f32 v34, v34, v28, v29
    v_max3_f32 v34, v34, v30, v31
    s_nop 1
    v_mfma_f32_32x32x16_bf16 v[16:31], v[84:87], v[76:79], 0
    s_nop 15
    v_max3_f32 v34, v34, v16, v17
    v_max3_f32 v34, v34, v18, v19
    v_max3_f32 v34, v34, v20, v21
    v_max3_f32 v34, v34, v22, v23
    v_max3_f32 v34, v34, v24, v25
    v_max3_f32 v34, v34, v26, v27
    v_max3_f32 v34, v34, v28, v29
    v_max3_f32 v34, v34, v30, v31
    s_nop 1
    v_mfma_f32_32x32x16_bf16 v[16:31], v[88:91], v[76:79], 0
    s_nop 15
    v_max3_f32 v34, v34, v16, v17
    v_max3_f32 v34, v34, v18, v19
    v_max3_f32 v34, v34, v20, v21
    v_max3_f32 v34, v34, v22, v23
    v_max3_f32 v34, v34, v24, v25
    v_max3_f32 v34, v34, v26, v27
    v_max3_f32 v34, v34, v28, v29
    v_max3_f32 v34, v34, v30, v31
    s_nop 1
    v_mfma_f32_32x32x16_bf16 v[16:31], v[92:95], v[76:79], 0
    s_nop 15
    v_max3_f32 v34, v34, v16, v17
    v_max3_f32 v34, v34, v18, v19
    v_max3_f32 v34, v34, v20, v21
    v_max3_f32 v34, v34, v22, v23
    v_max3_f32 v34, v34, v24, v25
    v_max3_f32 v34, v34, v26, v27
    v_max3_f32 v34, v34, v28, v29
    v_max3_f32 v34, v34, v30, v31
    s_nop 1
    v_mfma_f32_32x32x16_bf16 v[16:31], v[96:99], v[76:79], 0
    s_nop 15
    v_max3_f32 v34, v34, v16, v17
    v_max3_f32 v34, v34, v18, v19
    v_max3_f32 v34, v34, v20, v21
    v_max3_f32 v34, v34, v22, v23
    v_max3_f32 v34, v34, v24, v25
    v_max3_f32 v34, v34, v26, v27
    v_max3_f32 v34, v34, v28, v29
    v_max3_f32 v34, v34, v30, v31
    s_nop 1
    v_mfma_f32_32x32x16_bf16 v[16:31], v[100:103], v[76:79], 0
    s_nop 15
    v_max3_f32 v34, v34, v16, v17
    v_max3_f32 v34, v34, v18, v19
    v_max3_f32 v34, v34, v20, v21
    v_max3_f32 v34, v34, v22, v23
    v_max3_f32 v34, v34, v24, v25
    v_max3_f32 v34, v34, v26, v27
    v_max3_f32 v34, v34, v28, v29
    v_max3_f32 v34, v34, v30, v31
    s_nop 1
    v_mfma_f32_32x32x16_bf16 v[16:31], v[104:107], v[76:79], 0
    s_nop 15
    v_max3_f32 v34, v34, v16, v17
    v_max3_f32 v34, v34, v18, v19
    v_max3_f32 v34, v34, v20, v21
    v_max3_f32 v34, v34, v22, v23
    v_max3_f32 v34, v34, v24, v25
    v_max3_f32 v34, v34, v26, v27
    v_max3_f32 v34, v34, v28, v29
    v_max3_f32 v34, v34, v30, v31
    s_nop 1
    v_mfma_f32_32x32x16_bf16 v[16:31], v[108:111], v[76:79], 0
    s_nop 15
    v_max3_f32 v34, v34, v16, v17
    v_max3_f32 v34, v34, v18, v19
    v_max3_f32 v34, v34, v20, v21
    v_max3_f32 v34, v34, v22, v23
    v_max3_f32 v34, v34, v24, v25
    v_max3_f32 v34, v34, v26, v27
    v_max3_f32 v34, v34, v28, v29
    v_max3_f32 v34, v34, v30, v31
    s_nop 1
    s_add_u32 s50, s59, 3072
    buffer_load_dwordx4 v[76:79], v2, s[20:23], s50 offen sc1
    s_waitcnt vmcnt(0)
    v_mfma_f32_32x32x16_bf16 v[16:31], v[80:83], v[76:79], 0
    s_nop 15
    v_max3_f32 v35, v35, v16, v17
    v_max3_f32 v35, v35, v18, v19
    v_max3_f32 v35, v35, v20, v21
    v_max3_f32 v35, v35, v22, v23
    v_max3_f32 v35, v35, v24, v25
    v_max3_f32 v35, v35, v26, v27
    v_max3_f32 v35, v35, v28, v29
    v_max3_f32 v35, v35, v30, v31
    s_nop 1
    v_mfma_f32_32x32x16_bf16 v[16:31], v[84:87], v[76:79], 0
    s_nop 15
    v_max3_f32 v35, v35, v16, v17
    v_max3_f32 v35, v35, v18, v19
    v_max3_f32 v35, v35, v20, v21
    v_max3_f32 v35, v35, v22, v23
    v_max3_f32 v35, v35, v24, v25
    v_max3_f32 v35, v35, v26, v27
    v_max3_f32 v35, v35, v28, v29
    v_max3_f32 v35, v35, v30, v31
    s_nop 1
    v_mfma_f32_32x32x16_bf16 v[16:31], v[88:91], v[76:79], 0
    s_nop 15
    v_max3_f32 v35, v35, v16, v17
    v_max3_f32 v35, v35, v18, v19
    v_max3_f32 v35, v35, v20, v21
    v_max3_f32 v35, v35, v22, v23
    v_max3_f32 v35, v35, v24, v25
    v_max3_f32 v35, v35, v26, v27
    v_max3_f32 v35, v35, v28, v29
    v_max3_f32 v35, v35, v30, v31
    s_nop 1
    v_mfma_f32_32x32x16_bf16 v[16:31], v[92:95], v[76:79], 0
    s_nop 15
    v_max3_f32 v35, v35, v16, v17
    v_max3_f32 v35, v35, v18, v19
    v_max3_f32 v35, v35, v20, v21
    v_max3_f32 v35, v35, v22, v23
    v_max3_f32 v35, v35, v24, v25
    v_max3_f32 v35, v35, v26, v27
    v_max3_f32 v35, v35, v28, v29
    v_max3_f32 v35, v35, v30, v31
    s_nop 1
    v_mfma_f32_32x32x16_bf16 v[16:31], v[96:99], v[76:79], 0
    s_nop 15
    v_max3_f32 v35, v35, v16, v17
    v_max3_f32 v35, v35, v18, v19
    v_max3_f32 v35, v35, v20, v21
    v_max3_f32 v35, v35, v22, v23
    v_max3_f32 v35, v35, v24, v25
    v_max3_f32 v35, v35, v26, v27
    v_max3_f32 v35, v35, v28, v29
    v_max3_f32 v35, v35, v30, v31
    s_nop 1
    v_mfma_f32_32x32x16_bf16 v[16:31], v[100:103], v[76:79], 0
    s_nop 15
    v_max3_f32 v35, v35, v16, v17
    v_max3_f32 v35, v35, v18, v19
    v_max3_f32 v35, v35, v20, v21
    v_max3_f32 v35, v35, v22, v23
    v_max3_f32 v35, v35, v24, v25
    v_max3_f32 v35, v35, v26, v27
    v_max3_f32 v35, v35, v28, v29
    v_max3_f32 v35, v35, v30, v31
    s_nop 1
    v_mfma_f32_32x32x16_bf16 v[16:31], v[104:107], v[76:79], 0
    s_nop 15
    v_max3_f32 v35, v35, v16, v17
    v_max3_f32 v35, v35, v18, v19
    v_max3_f32 v35, v35, v20, v21
    v_max3_f32 v35, v35, v22, v23
    v_max3_f32 v35, v35, v24, v25
    v_max3_f32 v35, v35, v26, v27
    v_max3_f32 v35, v35, v28, v29
    v_max3_f32 v35, v35, v30, v31
    s_nop 1
    v_mfma_f32_32x32x16_bf16 v[16:31], v[108:111], v[76:79], 0
    s_nop 15
    v_max3_f32 v35, v35, v16, v17
    v_max3_f32 v35, v35, v18, v19
    v_max3_f32 v35, v35, v20, v21
    v_max3_f32 v35, v35, v22, v23
    v_max3_f32 v35, v35, v24, v25
    v_max3_f32 v35, v35, v26, v27
    v_max3_f32 v35, v35, v28, v29
    v_max3_f32 v35, v35, v30, v31
    s_nop 1
    s_add_u32 s51, s51, 8192
    s_add_u32 s39, s39, 1
    s_cmp_lt_u32 s39, 2
    s_cbranch_scc1 SLOWP_H
    v_mov_b32 v36, v32
    s_nop 1
    v_permlane32_swap_b32 v32, v36
    s_nop 1
    v_max_f32 v32, v32, v36
    ds_write_b32 v38, v32 offset:0
    v_mov_b32 v36, v33
    s_nop 1
    v_permlane32_swap_b32 v33, v36
    s_nop 1
    v_max_f32 v33, v33, v36
    ds_write_b32 v38, v33 offset:128
    v_mov_b32 v36, v34
    s_nop 1
    v_permlane32_swap_b32 v34, v36
    s_nop 1
    v_max_f32 v34, v34, v36
    ds_write_b32 v38, v34 offset:256
    v_mov_b32 v36, v35
    s_nop 1
    v_permlane32_swap_b32 v35, v36
    s_nop 1
    v_max_f32 v35, v35, v36
    ds_write_b32 v38, v35 offset:384
    s_sub_u32 s51, s42, 4096
    s_add_u32 s50, s51, 0
    buffer_load_dwordx4 v[80:83], v2, s[20:23], s50 offen sc1
    s_add_u32 s50, s51, 1024
    buffer_load_dwordx4 v[84:87], v2, s[20:23], s50 offen sc1
    s_add_u32 s50, s51, 2048
    buffer_load_dwordx4 v[88:91], v2, s[20:23], s50 offen sc1
    s_add_u32 s50, s51, 3072
    buffer_load_dwordx4 v[92:95], v2, s[20:23], s50 offen sc1
    s_add_u32 s50, s51, 4096
    buffer_load_dwordx4 v[96:99], v2, s[20:23], s50 offen sc1
    s_add_u32 s50, s51, 5120
    buffer_load_dwordx4 v[100:103], v2, s[20:23], s50 offen sc1
    s_add_u32 s50, s51, 6144
    buffer_load_dwordx4 v[104:107], v2, s[20:23], s50 offen sc1
    s_add_u32 s50, s51, 7168
    buffer_load_dwordx4 v[108:111], v2, s[20:23], s50 offen sc1
    s_waitcnt vmcnt(0) lgkmcnt(0)
    s_barrier
    s_cmp_eq_u32 s60, 0
    s_cbranch_scc1 SLOWC_P
    ds_read_b32 v40, v13 offset:0
    ds_read_b32 v41, v13 offset:1024
    ds_read_b32 v42, v13 offset:2048
    ds_read_b32 v43, v13 offset:3072
    s_waitcnt lgkmcnt(0)
    v_max_f32 v40, v40, v41
    v_max_f32 v40, v40, v42
    v_max_f32 v40, v40, v43
    v_sub_f32 v40, 0, v40
    s_nop 7
    v_mov_b32 v48, v40
    v_mov_b32 v49, v40
    v_mov_b32 v50, v40
    v_mov_b32 v51, v40
    v_mov_b32 v52, v40
    v_mov_b32 v53, v40
    v_mov_b32 v54, v40
    v_mov_b32 v55, v40
    v_mov_b32 v56, v40
    v_mov_b32 v57, v40
    v_mov_b32 v58, v40
    v_mov_b32 v59, v40
    v_mov_b32 v60, v40
    v_mov_b32 v61, v40
    v_mov_b32 v62, v40
    v_mov_b32 v63, v40
    s_nop 1
SLOWC_P:
SLOWP_END:
    v_mov_b32 v32, 0
    v_mov_b32 v33, 0
    v_mov_b32 v34, 0
    v_mov_b32 v35, 0
    v_mov_b32 v36, 0
    v_mov_b32 v37, 0
    v_mov_b32 v38, 0
    v_mov_b32 v39, 0
    v_mov_b32 v40, 0
    v_mov_b32 v41, 0
    v_mov_b32 v42, 0
    v_mov_b32 v43, 0
    v_mov_b32 v44, 0
    v_mov_b32 v45, 0
    v_mov_b32 v46, 0
    v_mov_b32 v47, 0
    v_mov_b32 v64, 0
    v_mov_b32 v65, 0
    v_mov_b32 v66, 0
    v_mov_b32 v67, 0
    v_mov_b32 v68, 0
    v_mov_b32 v69, 0
    v_mov_b32 v70, 0
    v_mov_b32 v71, 0
    v_mov_b32 v76, 0
    v_mov_b32 v77, 0
    v_mov_b32 v78, 0
    v_mov_b32 v79, 0
    s_nop 1
    v_mfma_f32_32x32x16_bf16 v[128:143], v[76:79], v[76:79], 0
    v_mfma_f32_32x32x16_bf16 v[144:159], v[76:79], v[76:79], 0
    v_mfma_f32_32x32x16_bf16 v[112:127], v[76:79], v[76:79], 0
    v_mfma_f32_32x32x16_bf16 v[16:31], v[80:83], v[72:75], v[48:63]
    s_nop 15
    v_exp_f32 v16, v16
    v_cvt_pk_bf16_f32 v71, v46, v47
    s_add_u32 s48, s59, 1024
    buffer_load_dwordx4 v[76:79], v2, s[20:23], s48 offen sc1
    v_exp_f32 v17, v17
    v_exp_f32 v18, v18
    v_mfma_f32_32x32x16_bf16 v[112:127], a[60:63], v[68:71], v[112:127]
    v_cvt_pk_bf16_f32 v64, v16, v17
    v_exp_f32 v19, v19
    v_exp_f32 v20, v20
    v_cvt_pk_bf16_f32 v65, v18, v19
    v_mfma_f32_32x32x16_bf16 v[32:47], v[84:87], v[72:75], v[48:63]
    v_exp_f32 v21, v21
    v_exp_f32 v22, v22
    v_cvt_pk_bf16_f32 v66, v20, v21
    v_exp_f32 v23, v23
    v_exp_f32 v24, v24
    v_cvt_pk_bf16_f32 v67, v22, v23
    v_exp_f32 v25, v25
    v_exp_f32 v26, v26
    v_mfma_f32_32x32x16_bf16 v[112:127], a[0:3], v[64:67], 0
    v_cvt_pk_bf16_f32 v68, v24, v25
    v_exp_f32 v27, v27
    v_exp_f32 v28, v28
    v_cvt_pk_bf16_f32 v69, v26, v27
    v_exp_f32 v29, v29
    v_exp_f32 v30, v30
    v_cvt_pk_bf16_f32 v70, v28, v29
    v_exp_f32 v31, v31
    v_exp_f32 v32, v32
    v_cvt_pk_bf16_f32 v71, v30, v31
    v_exp_f32 v33, v33
    v_exp_f32 v34, v34
    v_mfma_f32_32x32x16_bf16 v[112:127], a[4:7], v[68:71], v[112:127]
    v_cvt_pk_bf16_f32 v64, v32, v33
    v_exp_f32 v35, v35
    v_exp_f32 v36, v36
    v_cvt_pk_bf16_f32 v65, v34, v35
    v_mfma_f32_32x32x16_bf16 v[16:31], v[88:91], v[72:75], v[48:63]
    v_exp_f32 v37, v37
    v_exp_f32 v38, v38
    v_cvt_pk_bf16_f32 v66, v36, v37
    v_exp_f32 v39, v39
    v_exp_f32 v40, v40
    v_cvt_pk_bf16_f32 v67, v38, v39
    v_exp_f32 v41, v41
    v_exp_f32 v42, v42
    v_mfma_f32_32x32x16_bf16 v[112:127], a[8:11], v[64:67], v[112:127]
    v_cvt_pk_bf16_f32 v68, v40, v41
    v_exp_f32 v43, v43
    v_exp_f32 v44, v44
    v_cvt_pk_bf16_f32 v69, v42, v43
    v_exp_f32 v45, v45
    v_exp_f32 v46, v46
    v_cvt_pk_bf16_f32 v70, v44, v45
    v_exp_f32 v47, v47
    v_exp_f32 v16, v16
    v_cvt_pk_bf16_f32 v71, v46, v47
    v_exp_f32 v17, v17
    v_exp_f32 v18, v18
    v_mfma_f32_32x32x16_bf16 v[112:127], a[12:15], v[68:71], v[112:127]
    v_cvt_pk_bf16_f32 v64, v16, v17
    v_exp_f32 v19, v19
    v_exp_f32 v20, v20
    v_cvt_pk_bf16_f32 v65, v18, v19
    v_mfma_f32_32x32x16_bf16 v[32:47], v[92:95], v[72:75], v[48:63]
    v_exp_f32 v21, v21
    v_exp_f32 v22, v22
    v_cvt_pk_bf16_f32 v66, v20, v21
    v_exp_f32 v23, v23
    v_exp_f32 v24, v24
    v_cvt_pk_bf16_f32 v67, v22, v23
    v_exp_f32 v25, v25
    v_exp_f32 v26, v26
    v_mfma_f32_32x32x16_bf16 v[112:127], a[16:19], v[64:67], v[112:127]
    v_cvt_pk_bf16_f32 v68, v24, v25
    v_exp_f32 v27, v27
    v_exp_f32 v28, v28
    v_cvt_pk_bf16_f32 v69, v26, v27
    v_exp_f32 v29, v29
    v_exp_f32 v30, v30
    v_cvt_pk_bf16_f32 v70, v28, v29
    v_exp_f32 v31, v31
    v_exp_f32 v32, v32
    v_cvt_pk_bf16_f32 v71, v30, v31
    v_exp_f32 v33, v33
    v_exp_f32 v34, v34
    v_mfma_f32_32x32x16_bf16 v[112:127], a[20:23], v[68:71], v[112:127]
    v_cvt_pk_bf16_f32 v64, v32, v33
    v_exp_f32 v35, v35
    v_exp_f32 v36, v36
    v_cvt_pk_bf16_f32 v65, v34, v35
    v_mfma_f32_32x32x16_bf16 v[16:31], v[96:99], v[72:75], v[48:63]
    v_exp_f32 v37, v37
    v_exp_f32 v38, v38
    v_cvt_pk_bf16_f32 v66, v36, v37
    v_exp_f32 v39, v39
    v_exp_f32 v40, v40
    v_cvt_pk_bf16_f32 v67, v38, v39
    v_exp_f32 v41, v41
    v_exp_f32 v42, v42
    v_mfma_f32_32x32x16_bf16 v[112:127], a[24:27], v[64:67], v[112:127]
    v_cvt_pk_bf16_f32 v68, v40, v41
    v_exp_f32 v43, v43
    v_exp_f32 v44, v44
    v_cvt_pk_bf16_f32 v69, v42, v43
    v_exp_f32 v45, v45
    v_exp_f32 v46, v46
    v_cvt_pk_bf16_f32 v70, v44, v45
    v_exp_f32 v47, v47
    v_exp_f32 v16, v16
    v_cvt_pk_bf16_f32 v71, v46, v47
    v_exp_f32 v17, v17
    v_exp_f32 v18, v18
    v_mfma_f32_32x32x16_bf16 v[112:127], a[28:31], v[68:71], v[112:127]
    v_cvt_pk_bf16_f32 v64, v16, v17
    v_exp_f32 v19, v19
    v_exp_f32 v20, v20
    v_cvt_pk_bf16_f32 v65, v18, v19
    v_mfma_f32_32x32x16_bf16 v[32:47], v[100:103], v[72:75], v[48:63]
    v_exp_f32 v21, v21
    v_exp_f32 v22, v22
    v_cvt_pk_bf16_f32 v66, v20, v21
    v_exp_f32 v23, v23
    v_exp_f32 v24, v24
    v_cvt_pk_bf16_f32 v67, v22, v23
    v_exp_f32 v25, v25
    v_exp_f32 v26, v26
    v_mfma_f32_32x32x16_bf16 v[112:127], a[32:35], v[64:67], v[112:127]
    v_cvt_pk_bf16_f32 v68, v24, v25
    v_exp_f32 v27, v27
    v_exp_f32 v28, v28
    v_cvt_pk_bf16_f32 v69, v26, v27
    v_exp_f32 v29, v29
    v_exp_f32 v30, v30
    v_cvt_pk_bf16_f32 v70, v28, v29
    v_exp_f32 v31, v31
    v_exp_f32 v32, v32
    v_cvt_pk_bf16_f32 v71, v30, v31
    v_exp_f32 v33, v33
    v_exp_f32 v34, v34
    v_mfma_f32_32x32x16_bf16 v[112:127], a[36:39], v[68:71], v[112:127]
    v_cvt_pk_bf16_f32 v64, v32, v33
    v_exp_f32 v35, v35
    v_exp_f32 v36, v36
    v_cvt_pk_bf16_f32 v65, v34, v35
    v_mfma_f32_32x32x16_bf16 v[16:31], v[104:107], v[72:75], v[48:63]
    v_exp_f32 v37, v37
    v_exp_f32 v38, v38
    v_cvt_pk_bf16_f32 v66, v36, v37
    v_exp_f32 v39, v39
    v_exp_f32 v40, v40
    v_cvt_pk_bf16_f32 v67, v38, v39
    v_exp_f32 v41, v41
    v_exp_f32 v42, v42
    v_mfma_f32_32x32x16_bf16 v[112:127], a[40:43], v[64:67], v[112:127]
    v_cvt_pk_bf16_f32 v68, v40, v41
    v_exp_f32 v43, v43
    v_exp_f32 v44, v44
    v_cvt_pk_bf16_f32 v69, v42, v43
    v_exp_f32 v45, v45
    v_exp_f32 v46, v46
    v_cvt_pk_bf16_f32 v70, v44, v45
    v_exp_f32 v47, v47
    v_exp_f32 v16, v16
    v_cvt_pk_bf16_f32 v71, v46, v47
    v_exp_f32 v17, v17
    v_exp_f32 v18, v18
    v_mfma_f32_32x32x16_bf16 v[112:127], a[44:47], v[68:71], v[112:127]
    v_cvt_pk_bf16_f32 v64, v16, v17
    v_exp_f32 v19, v19
    v_exp_f32 v20, v20
    v_cvt_pk_bf16_f32 v65, v18, v19
    v_mfma_f32_32x32x16_bf16 v[32:47], v[108:111], v[72:75], v[48:63]
    v_exp_f32 v21, v21
    v_exp_f32 v22, v22
    v_cvt_pk_bf16_f32 v66, v20, v21
    v_exp_f32 v23, v23
    v_exp_f32 v24, v24
    v_cvt_pk_bf16_f32 v67, v22, v23
    v_exp_f32 v25, v25
    v_exp_f32 v26, v26
    v_mfma_f32_32x32x16_bf16 v[112:127], a[48:51], v[64:67], v[112:127]
    v_cvt_pk_bf16_f32 v68, v24, v25
    v_exp_f32 v27, v27
    v_exp_f32 v28, v28
    v_cvt_pk_bf16_f32 v69, v26, v27
    v_exp_f32 v29, v29
    v_exp_f32 v30, v30
    v_cvt_pk_bf16_f32 v70, v28, v29
    v_exp_f32 v31, v31
    s_cmp_eq_u32 s60, 0
    s_cbranch_scc1 SLOWC_I0
    ds_read_b32 v16, v13 offset:128
    ds_read_b32 v17, v13 offset:1152
    ds_read_b32 v18, v13 offset:2176
    ds_read_b32 v19, v13 offset:3200
    s_waitcnt lgkmcnt(0)
    v_max_f32 v16, v16, v17
    v_max_f32 v16, v16, v18
    v_max_f32 v16, v16, v19
    v_sub_f32 v16, 0, v16
    s_nop 7
    v_mov_b32 v48, v16
    v_mov_b32 v49, v16
    v_mov_b32 v50, v16
    v_mov_b32 v51, v16
    v_mov_b32 v52, v16
    v_mov_b32 v53, v16
    v_mov_b32 v54, v16
    v_mov_b32 v55, v16
    v_mov_b32 v56, v16
    v_mov_b32 v57, v16
    v_mov_b32 v58, v16
    v_mov_b32 v59, v16
    v_mov_b32 v60, v16
    v_mov_b32 v61, v16
    v_mov_b32 v62, v16
    v_mov_b32 v63, v16
    s_nop 1
SLOWC_I0:
    v_exp_f32 v32, v32
    s_waitcnt vmcnt(0)
    v_cvt_pk_bf16_f32 v71, v30, v31
    v_exp_f32 v33, v33
    v_exp_f32 v34, v34
    v_mfma_f32_32x32x16_bf16 v[112:127], a[52:55], v[68:71], v[112:127]
    v_cvt_pk_bf16_f32 v64, v32, v33
    v_exp_f32 v35, v35
    v_exp_f32 v36, v36
    v_cvt_pk_bf16_f32 v65, v34, v35
    v_mfma_f32_32x32x16_bf16 v[16:31], v[80:83], v[76:79], v[48:63]
    v_exp_f32 v37, v37
    v_exp_f32 v38, v38
    v_cvt_pk_bf16_f32 v66, v36, v37
    v_exp_f32 v39, v39
    v_exp_f32 v40, v40
    v_cvt_pk_bf16_f32 v67, v38, v39
    v_exp_f32 v41, v41
    v_exp_f32 v42, v42
    v_mfma_f32_32x32x16_bf16 v[112:127], a[56:59], v[64:67], v[112:127]
    v_cvt_pk_bf16_f32 v68, v40, v41
    v_exp_f32 v43, v43
    v_exp_f32 v44, v44
    v_cvt_pk_bf16_f32 v69, v42, v43
    v_exp_f32 v45, v45
    v_exp_f32 v46, v46
    v_cvt_pk_bf16_f32 v70, v44, v45
    v_exp_f32 v47, v47
    v_exp_f32 v16, v16
    v_cvt_pk_bf16_f32 v71, v46, v47
    s_add_u32 s48, s59, 2048
    buffer_load_dwordx4 v[72:75], v2, s[20:23], s48 offen sc1
    v_exp_f32 v17, v17
    v_exp_f32 v18, v18
    v_mfma_f32_32x32x16_bf16 v[112:127], a[60:63], v[68:71], v[112:127]
    v_cvt_pk_bf16_f32 v64, v16, v17
    v_exp_f32 v19, v19
    v_exp_f32 v20, v20
    v_cvt_pk_bf16_f32 v65, v18, v19
    v_mfma_f32_32x32x16_bf16 v[32:47], v[84:87], v[76:79], v[48:63]
    v_exp_f32 v21, v21
    v_exp_f32 v22, v22
    v_cvt_pk_bf16_f32 v66, v20, v21
    v_exp_f32 v23, v23
    v_exp_f32 v24, v24
    v_cvt_pk_bf16_f32 v67, v22, v23
    v_exp_f32 v25, v25
    ds_write_b128 v6, v[112:115] offset:0
    ds_write_b128 v6, v[116:119] offset:1024
    ds_write_b32 v0, v120 offset:2048
    v_exp_f32 v26, v26
    v_mfma_f32_32x32x16_bf16 v[112:127], a[0:3], v[64:67], 0
    v_cvt_pk_bf16_f32 v68, v24, v25
    v_exp_f32 v27, v27
    v_exp_f32 v28, v28
    v_cvt_pk_bf16_f32 v69, v26, v27
    v_exp_f32 v29, v29
    v_exp_f32 v30, v30
    v_cvt_pk_bf16_f32 v70, v28, v29
    v_exp_f32 v31, v31
    v_exp_f32 v32, v32
    v_cvt_pk_bf16_f32 v71, v30, v31
    v_exp_f32 v33, v33
    v_exp_f32 v34, v34
    v_mfma_f32_32x32x16_bf16 v[112:127], a[4:7], v[68:71], v[112:127]
    v_cvt_pk_bf16_f32 v64, v32, v33
    v_exp_f32 v35, v35
    v_exp_f32 v36, v36
    v_cvt_pk_bf16_f32 v65, v34, v35
    v_mfma_f32_32x32x16_bf16 v[16:31], v[88:91], v[76:79], v[48:63]
    v_exp_f32 v37, v37
    v_exp_f32 v38, v38
    v_cvt_pk_bf16_f32 v66, v36, v37
    v_exp_f32 v39, v39
    v_exp_f32 v40, v40
    v_cvt_pk_bf16_f32 v67, v38, v39
    v_exp_f32 v41, v41
    v_exp_f32 v42, v42
    v_mfma_f32_32x32x16_bf16 v[112:127], a[8:11], v[64:67], v[112:127]
    v_cvt_pk_bf16_f32 v68, v40, v41
    v_exp_f32 v43, v43
    v_exp_f32 v44, v44
    v_cvt_pk_bf16_f32 v69, v42, v43
    v_exp_f32 v45, v45
    v_exp_f32 v46, v46
    v_cvt_pk_bf16_f32 v70, v44, v45
    v_exp_f32 v47, v47
    v_exp_f32 v16, v16
    v_cvt_pk_bf16_f32 v71, v46, v47
    v_exp_f32 v17, v17
    v_exp_f32 v18, v18
    v_mfma_f32_32x32x16_bf16 v[112:127], a[12:15], v[68:71], v[112:127]
    v_cvt_pk_bf16_f32 v64, v16, v17
    s_mov_b32 s44, s68
    s_mov_b32 s45, s69
    s_mov_b32 s46, 0x80000
    s_mov_b32 s47, 0x00020000
    s_lshr_b32 s48, s2, 3
    s_lshl_b32 s48, s48, 3
    s_add_u32 s48, s48, s24
    s_lshl_b32 s49, s48, 11
    v_and_b32 v3, 15, v1
    v_lshlrev_b32 v3, 7, v3
    buffer_load_dword v5, v3, s[44:47], s49 offen
    v_exp_f32 v19, v19
    v_exp_f32 v20, v20
    v_cvt_pk_bf16_f32 v65, v18, v19
    v_mfma_f32_32x32x16_bf16 v[32:47], v[92:95], v[76:79], v[48:63]
    v_exp_f32 v21, v21
    v_exp_f32 v22, v22
    v_cvt_pk_bf16_f32 v66, v20, v21
    v_exp_f32 v23, v23
    v_exp_f32 v24, v24
    v_cvt_pk_bf16_f32 v67, v22, v23
    v_exp_f32 v25, v25
    v_exp_f32 v26, v26
    v_mfma_f32_32x32x16_bf16 v[112:127], a[16:19], v[64:67], v[112:127]
    v_cvt_pk_bf16_f32 v68, v24, v25
    v_exp_f32 v27, v27
    v_exp_f32 v28, v28
    v_cvt_pk_bf16_f32 v69, v26, v27
    v_exp_f32 v29, v29
    v_exp_f32 v30, v30
    v_cvt_pk_bf16_f32 v70, v28, v29
    v_exp_f32 v31, v31
    v_exp_f32 v32, v32
    v_cvt_pk_bf16_f32 v71, v30, v31
    v_exp_f32 v33, v33
    v_exp_f32 v34, v34
    v_mfma_f32_32x32x16_bf16 v[112:127], a[20:23], v[68:71], v[112:127]
    v_cvt_pk_bf16_f32 v64, v32, v33
    v_exp_f32 v35, v35
    v_exp_f32 v36, v36
    v_cvt_pk_bf16_f32 v65, v34, v35
    v_mfma_f32_32x32x16_bf16 v[16:31], v[96:99], v[76:79], v[48:63]
    v_exp_f32 v37, v37
    v_exp_f32 v38, v38
    v_cvt_pk_bf16_f32 v66, v36, v37
    v_exp_f32 v39, v39
    v_exp_f32 v40, v40
    v_cvt_pk_bf16_f32 v67, v38, v39
    v_exp_f32 v41, v41
    v_exp_f32 v42, v42
    v_mfma_f32_32x32x16_bf16 v[112:127], a[24:27], v[64:67], v[112:127]
    v_cvt_pk_bf16_f32 v68, v40, v41
    v_exp_f32 v43, v43
    v_exp_f32 v44, v44
    v_cvt_pk_bf16_f32 v69, v42, v43
    v_exp_f32 v45, v45
    v_exp_f32 v46, v46
    v_cvt_pk_bf16_f32 v70, v44, v45
    v_exp_f32 v47, v47
    v_exp_f32 v16, v16
    v_cvt_pk_bf16_f32 v71, v46, v47
    v_exp_f32 v17, v17
    v_exp_f32 v18, v18
    v_mfma_f32_32x32x16_bf16 v[112:127], a[28:31], v[68:71], v[112:127]
    v_cvt_pk_bf16_f32 v64, v16, v17
    v_exp_f32 v19, v19
    v_exp_f32 v20, v20
    v_cvt_pk_bf16_f32 v65, v18, v19
    v_mfma_f32_32x32x16_bf16 v[32:47], v[100:103], v[76:79], v[48:63]
    v_exp_f32 v21, v21
    v_exp_f32 v22, v22
    v_cvt_pk_bf16_f32 v66, v20, v21
    v_exp_f32 v23, v23
    v_exp_f32 v24, v24
    v_cvt_pk_bf16_f32 v67, v22, v23
    v_exp_f32 v25, v25
    v_exp_f32 v26, v26
    v_mfma_f32_32x32x16_bf16 v[112:127], a[32:35], v[64:67], v[112:127]
    v_cvt_pk_bf16_f32 v68, v24, v25
    v_exp_f32 v27, v27
    v_exp_f32 v28, v28
    v_cvt_pk_bf16_f32 v69, v26, v27
    v_exp_f32 v29, v29
    v_exp_f32 v30, v30
    v_cvt_pk_bf16_f32 v70, v28, v29
    v_exp_f32 v31, v31
    v_exp_f32 v32, v32
    v_cvt_pk_bf16_f32 v71, v30, v31
    v_exp_f32 v33, v33
    v_exp_f32 v34, v34
    v_mfma_f32_32x32x16_bf16 v[112:127], a[36:39], v[68:71], v[112:127]
    v_cvt_pk_bf16_f32 v64, v32, v33
    v_exp_f32 v35, v35
    v_exp_f32 v36, v36
    v_cvt_pk_bf16_f32 v65, v34, v35
    v_mfma_f32_32x32x16_bf16 v[16:31], v[104:107], v[76:79], v[48:63]
    v_exp_f32 v37, v37
    v_exp_f32 v38, v38
    v_cvt_pk_bf16_f32 v66, v36, v37
    v_exp_f32 v39, v39
    v_exp_f32 v40, v40
    v_cvt_pk_bf16_f32 v67, v38, v39
    v_exp_f32 v41, v41
    v_exp_f32 v42, v42
    v_mfma_f32_32x32x16_bf16 v[112:127], a[40:43], v[64:67], v[112:127]
    v_cvt_pk_bf16_f32 v68, v40, v41
    v_exp_f32 v43, v43
    v_exp_f32 v44, v44
    v_cvt_pk_bf16_f32 v69, v42, v43
    v_exp_f32 v45, v45
    v_exp_f32 v46, v46
    v_cvt_pk_bf16_f32 v70, v44, v45
    v_exp_f32 v47, v47
    v_exp_f32 v16, v16
    v_cvt_pk_bf16_f32 v71, v46, v47
    v_exp_f32 v17, v17
    v_exp_f32 v18, v18
    v_mfma_f32_32x32x16_bf16 v[112:127], a[44:47], v[68:71], v[112:127]
    v_cvt_pk_bf16_f32 v64, v16, v17
    v_exp_f32 v19, v19
    v_exp_f32 v20, v20
    v_cvt_pk_bf16_f32 v65, v18, v19
    v_mfma_f32_32x32x16_bf16 v[32:47], v[108:111], v[76:79], v[48:63]
    v_exp_f32 v21, v21
    v_exp_f32 v22, v22
    v_cvt_pk_bf16_f32 v66, v20, v21
    v_exp_f32 v23, v23
    v_exp_f32 v24, v24
    v_cvt_pk_bf16_f32 v67, v22, v23
    v_exp_f32 v25, v25
    v_exp_f32 v26, v26
    v_mfma_f32_32x32x16_bf16 v[112:127], a[48:51], v[64:67], v[112:127]
    v_cvt_pk_bf16_f32 v68, v24, v25
    v_exp_f32 v27, v27
    v_exp_f32 v28, v28
    v_cvt_pk_bf16_f32 v69, v26, v27
    v_exp_f32 v29, v29
    v_exp_f32 v30, v30
    v_cvt_pk_bf16_f32 v70, v28, v29
    v_exp_f32 v31, v31
    s_cmp_eq_u32 s60, 0
    s_cbranch_scc1 SLOWC_I1
    ds_read_b32 v16, v13 offset:256
    ds_read_b32 v17, v13 offset:1280
    ds_read_b32 v18, v13 offset:2304
    ds_read_b32 v19, v13 offset:3328
    s_waitcnt lgkmcnt(0)
    v_max_f32 v16, v16, v17
    v_max_f32 v16, v16, v18
    v_max_f32 v16, v16, v19
    v_sub_f32 v16, 0, v16
    s_nop 7
    v_mov_b32 v48, v16
    v_mov_b32 v49, v16
    v_mov_b32 v50, v16
    v_mov_b32 v51, v16
    v_mov_b32 v52, v16
    v_mov_b32 v53, v16
    v_mov_b32 v54, v16
    v_mov_b32 v55, v16
    v_mov_b32 v56, v16
    v_mov_b32 v57, v16
    v_mov_b32 v58, v16
    v_mov_b32 v59, v16
    v_mov_b32 v60, v16
    v_mov_b32 v61, v16
    v_mov_b32 v62, v16
    v_mov_b32 v63, v16
    s_nop 1
SLOWC_I1:
    v_exp_f32 v32, v32
    s_waitcnt vmcnt(1)
    v_cvt_pk_bf16_f32 v71, v30, v31
    v_exp_f32 v33, v33
    v_exp_f32 v34, v34
    v_mfma_f32_32x32x16_bf16 v[112:127], a[52:55], v[68:71], v[112:127]
    v_cvt_pk_bf16_f32 v64, v32, v33
    v_exp_f32 v35, v35
    v_exp_f32 v36, v36
    v_cvt_pk_bf16_f32 v65, v34, v35
    v_mfma_f32_32x32x16_bf16 v[16:31], v[80:83], v[72:75], v[48:63]
    v_exp_f32 v37, v37
    v_exp_f32 v38, v38
    v_cvt_pk_bf16_f32 v66, v36, v37
    v_exp_f32 v39, v39
    v_exp_f32 v40, v40
    v_cvt_pk_bf16_f32 v67, v38, v39
    v_exp_f32 v41, v41
    v_exp_f32 v42, v42
    v_mfma_f32_32x32x16_bf16 v[112:127], a[56:59], v[64:67], v[112:127]
    v_cvt_pk_bf16_f32 v68, v40, v41
    v_exp_f32 v43, v43
    v_exp_f32 v44, v44
    v_cvt_pk_bf16_f32 v69, v42, v43
    v_exp_f32 v45, v45
    v_exp_f32 v46, v46
    v_cvt_pk_bf16_f32 v70, v44, v45
    v_exp_f32 v47, v47
    v_exp_f32 v16, v16
    v_cvt_pk_bf16_f32 v71, v46, v47
    s_add_u32 s48, s59, 3072
    buffer_load_dwordx4 v[76:79], v2, s[20:23], s48 offen sc1
    v_exp_f32 v17, v17
    v_exp_f32 v18, v18
    v_mfma_f32_32x32x16_bf16 v[112:127], a[60:63], v[68:71], v[112:127]
    v_cvt_pk_bf16_f32 v64, v16, v17
    v_exp_f32 v19, v19
    v_exp_f32 v20, v20
    v_cvt_pk_bf16_f32 v65, v18, v19
    v_mfma_f32_32x32x16_bf16 v[32:47], v[84:87], v[72:75], v[48:63]
    v_exp_f32 v21, v21
    v_exp_f32 v22, v22
    v_cvt_pk_bf16_f32 v66, v20, v21
    v_exp_f32 v23, v23
    v_exp_f32 v24, v24
    v_cvt_pk_bf16_f32 v67, v22, v23
    v_exp_f32 v25, v25
    ds_write_b128 v6, v[112:115] offset:2304
    ds_write_b128 v6, v[116:119] offset:3328
    ds_write_b32 v0, v120 offset:4352
    v_exp_f32 v26, v26
    v_mfma_f32_32x32x16_bf16 v[112:127], a[0:3], v[64:67], 0
    v_cvt_pk_bf16_f32 v68, v24, v25
    v_exp_f32 v27, v27
    v_exp_f32 v28, v28
    v_cvt_pk_bf16_f32 v69, v26, v27
    v_exp_f32 v29, v29
    v_exp_f32 v30, v30
    v_cvt_pk_bf16_f32 v70, v28, v29
    v_exp_f32 v31, v31
    v_exp_f32 v32, v32
    v_cvt_pk_bf16_f32 v71, v30, v31
    v_exp_f32 v33, v33
    v_exp_f32 v34, v34
    v_mfma_f32_32x32x16_bf16 v[112:127], a[4:7], v[68:71], v[112:127]
    v_cvt_pk_bf16_f32 v64, v32, v33
    v_exp_f32 v35, v35
    v_exp_f32 v36, v36
    v_cvt_pk_bf16_f32 v65, v34, v35
    v_mfma_f32_32x32x16_bf16 v[16:31], v[88:91], v[72:75], v[48:63]
    v_exp_f32 v37, v37
    v_exp_f32 v38, v38
    v_cvt_pk_bf16_f32 v66, v36, v37
    v_exp_f32 v39, v39
    v_exp_f32 v40, v40
    v_cvt_pk_bf16_f32 v67, v38, v39
    v_exp_f32 v41, v41
    v_exp_f32 v42, v42
    v_mfma_f32_32x32x16_bf16 v[112:127], a[8:11], v[64:67], v[112:127]
    v_cvt_pk_bf16_f32 v68, v40, v41
    v_exp_f32 v43, v43
    v_exp_f32 v44, v44
    v_cvt_pk_bf16_f32 v69, v42, v43
    v_exp_f32 v45, v45
    v_exp_f32 v46, v46
    v_cvt_pk_bf16_f32 v70, v44, v45
    v_exp_f32 v47, v47
    v_exp_f32 v16, v16
    v_cvt_pk_bf16_f32 v71, v46, v47
    v_exp_f32 v17, v17
    v_exp_f32 v18, v18
    v_mfma_f32_32x32x16_bf16 v[112:127], a[12:15], v[68:71], v[112:127]
    v_cvt_pk_bf16_f32 v64, v16, v17
    buffer_load_dword v10, v11, s[20:23], s75 offen sc1
    v_exp_f32 v19, v19
    v_exp_f32 v20, v20
    v_cvt_pk_bf16_f32 v65, v18, v19
    v_mfma_f32_32x32x16_bf16 v[32:47], v[92:95], v[72:75], v[48:63]
    v_exp_f32 v21, v21
    v_exp_f32 v22, v22
    v_cvt_pk_bf16_f32 v66, v20, v21
    v_exp_f32 v23, v23
    v_exp_f32 v24, v24
    v_cvt_pk_bf16_f32 v67, v22, v23
    v_exp_f32 v25, v25
    v_exp_f32 v26, v26
    v_mfma_f32_32x32x16_bf16 v[112:127], a[16:19], v[64:67], v[112:127]
    v_cvt_pk_bf16_f32 v68, v24, v25
    v_exp_f32 v27, v27
    v_exp_f32 v28, v28
    v_cvt_pk_bf16_f32 v69, v26, v27
    v_exp_f32 v29, v29
    v_exp_f32 v30, v30
    v_cvt_pk_bf16_f32 v70, v28, v29
    v_exp_f32 v31, v31
    v_exp_f32 v32, v32
    v_cvt_pk_bf16_f32 v71, v30, v31
    v_exp_f32 v33, v33
    v_exp_f32 v34, v34
    v_mfma_f32_32x32x16_bf16 v[112:127], a[20:23], v[68:71], v[112:127]
    v_cvt_pk_bf16_f32 v64, v32, v33
    v_exp_f32 v35, v35
    v_exp_f32 v36, v36
    v_cvt_pk_bf16_f32 v65, v34, v35
    v_mfma_f32_32x32x16_bf16 v[16:31], v[96:99], v[72:75], v[48:63]
    v_exp_f32 v37, v37
    v_exp_f32 v38, v38
    v_cvt_pk_bf16_f32 v66, v36, v37
    v_exp_f32 v39, v39
    v_exp_f32 v40, v40
    v_cvt_pk_bf16_f32 v67, v38, v39
    v_exp_f32 v41, v41
    v_exp_f32 v42, v42
    v_mfma_f32_32x32x16_bf16 v[112:127], a[24:27], v[64:67], v[112:127]
    v_cvt_pk_bf16_f32 v68, v40, v41
    v_exp_f32 v43, v43
    v_exp_f32 v44, v44
    v_cvt_pk_bf16_f32 v69, v42, v43
    v_exp_f32 v45, v45
    v_exp_f32 v46, v46
    v_cvt_pk_bf16_f32 v70, v44, v45
    v_exp_f32 v47, v47
    v_exp_f32 v16, v16
    v_cvt_pk_bf16_f32 v71, v46, v47
    s_waitcnt vmcnt(0)
    v_cmp_ne_u32 vcc, s56, v10
    s_nop 3
    s_and_b32 vcc_lo, vcc_lo, 0x3fffffff
    s_and_b32 vcc_hi, vcc_hi, 0x3fffffff
    s_cmp_eq_u64 vcc, 0
    s_cbranch_scc1 S2_OK
    s_call_b64 s[0:1], S2_SPIN
S2_OK:
    v_exp_f32 v17, v17
    v_exp_f32 v18, v18
    v_mfma_f32_32x32x16_bf16 v[112:127], a[28:31], v[68:71], v[112:127]
    v_cvt_pk_bf16_f32 v64, v16, v17
    v_exp_f32 v19, v19
    v_exp_f32 v20, v20
    v_cvt_pk_bf16_f32 v65, v18, v19
    v_mfma_f32_32x32x16_bf16 v[32:47], v[100:103], v[72:75], v[48:63]
    v_exp_f32 v21, v21
    v_exp_f32 v22, v22
    v_cvt_pk_bf16_f32 v66, v20, v21
    v_exp_f32 v23, v23
    v_exp_f32 v24, v24
    v_cvt_pk_bf16_f32 v67, v22, v23
    v_exp_f32 v25, v25
    v_exp_f32 v26, v26
    v_mfma_f32_32x32x16_bf16 v[112:127], a[32:35], v[64:67], v[112:127]
    v_cvt_pk_bf16_f32 v68, v24, v25
    v_exp_f32 v27, v27
    v_exp_f32 v28, v28
    v_cvt_pk_bf16_f32 v69, v26, v27
    v_exp_f32 v29, v29
    v_exp_f32 v30, v30
    v_cvt_pk_bf16_f32 v70, v28, v29
    v_exp_f32 v31, v31
    v_exp_f32 v32, v32
    v_cvt_pk_bf16_f32 v71, v30, v31
    v_exp_f32 v33, v33
    v_exp_f32 v34, v34
    v_mfma_f32_32x32x16_bf16 v[112:127], a[36:39], v[68:71], v[112:127]
    v_cvt_pk_bf16_f32 v64, v32, v33
    s_add_u32 m0, s66, 0
    s_nop 0
    buffer_load_dwordx4 v7, s[12:15], s73 offen lds
    s_add_u32 s73, s73, 16384
    v_exp_f32 v35, v35
    v_exp_f32 v36, v36
    v_cvt_pk_bf16_f32 v65, v34, v35
    v_mfma_f32_32x32x16_bf16 v[16:31], v[104:107], v[72:75], v[48:63]
    v_exp_f32 v37, v37
    s_add_u32 m0, s66, 1024
    s_nop 0
    buffer_load_dwordx4 v7, s[12:15], s74 offen lds
    s_add_u32 s74, s74, 16384
    v_exp_f32 v38, v38
    v_cvt_pk_bf16_f32 v66, v36, v37
    v_exp_f32 v39, v39
    v_exp_f32 v40, v40
    v_cvt_pk_bf16_f32 v67, v38, v39
    v_exp_f32 v41, v41
    v_exp_f32 v42, v42
    v_mfma_f32_32x32x16_bf16 v[112:127], a[40:43], v[64:67], v[112:127]
    v_cvt_pk_bf16_f32 v68, v40, v41
    buffer_load_dwordx4 v[160:163], v2, s[8:11], s72 offen sc1
    s_add_u32 s72, s72, 1024
    v_exp_f32 v43, v43
    v_exp_f32 v44, v44
    v_cvt_pk_bf16_f32 v69, v42, v43
    v_exp_f32 v45, v45
    v_exp_f32 v46, v46
    v_cvt_pk_bf16_f32 v70, v44, v45
    v_exp_f32 v47, v47
    v_exp_f32 v16, v16
    v_cvt_pk_bf16_f32 v71, v46, v47
    v_exp_f32 v17, v17
    v_exp_f32 v18, v18
    v_mfma_f32_32x32x16_bf16 v[112:127], a[44:47], v[68:71], v[112:127]
    v_cvt_pk_bf16_f32 v64, v16, v17
    s_add_u32 m0, s66, 2048
    s_nop 0
    buffer_load_dwordx4 v7, s[12:15], s73 offen lds
    s_add_u32 s73, s73, 16384
    v_exp_f32 v19, v19
    v_exp_f32 v20, v20
    v_cvt_pk_bf16_f32 v65, v18, v19
    v_mfma_f32_32x32x16_bf16 v[32:47], v[108:111], v[72:75], v[48:63]
    v_exp_f32 v21, v21
    s_add_u32 m0, s66, 3072
    s_nop 0
    buffer_load_dwordx4 v7, s[12:15], s74 offen lds
    s_add_u32 s74, s74, 16384
    v_exp_f32 v22, v22
    v_cvt_pk_bf16_f32 v66, v20, v21
    v_exp_f32 v23, v23
    v_exp_f32 v24, v24
    v_cvt_pk_bf16_f32 v67, v22, v23
    v_exp_f32 v25, v25
    v_exp_f32 v26, v26
    v_mfma_f32_32x32x16_bf16 v[112:127], a[48:51], v[64:67], v[112:127]
    v_cvt_pk_bf16_f32 v68, v24, v25
    buffer_load_dwordx4 v[164:167], v2, s[8:11], s72 offen sc1
    s_add_u32 s72, s72, 1024
    v_exp_f32 v27, v27
    v_exp_f32 v28, v28
    v_cvt_pk_bf16_f32 v69, v26, v27
    v_exp_f32 v29, v29
    v_exp_f32 v30, v30
    v_cvt_pk_bf16_f32 v70, v28, v29
    v_exp_f32 v31, v31
    s_cmp_eq_u32 s60, 0
    s_cbranch_scc1 SLOWC_I2
    ds_read_b32 v16, v13 offset:384
    ds_read_b32 v17, v13 offset:1408
    ds_read_b32 v18, v13 offset:2432
    ds_read_b32 v19, v13 offset:3456
    s_waitcnt lgkmcnt(0)
    v_max_f32 v16, v16, v17
    v_max_f32 v16, v16, v18
    v_max_f32 v16, v16, v19
    v_sub_f32 v16, 0, v16
    s_nop 7
    v_mov_b32 v48, v16
    v_mov_b32 v49, v16
    v_mov_b32 v50, v16
    v_mov_b32 v51, v16
    v_mov_b32 v52, v16
    v_mov_b32 v53, v16
    v_mov_b32 v54, v16
    v_mov_b32 v55, v16
    v_mov_b32 v56, v16
    v_mov_b32 v57, v16
    v_mov_b32 v58, v16
    v_mov_b32 v59, v16
    v_mov_b32 v60, v16
    v_mov_b32 v61, v16
    v_mov_b32 v62, v16
    v_mov_b32 v63, v16
    s_nop 1
SLOWC_I2:
    v_exp_f32 v32, v32
    s_waitcnt vmcnt(7)
    v_cvt_pk_bf16_f32 v71, v30, v31
    v_exp_f32 v33, v33
    v_exp_f32 v34, v34
    v_mfma_f32_32x32x16_bf16 v[112:127], a[52:55], v[68:71], v[112:127]
    v_cvt_pk_bf16_f32 v64, v32, v33
    s_add_u32 m0, s66, 4096
    s_nop 0
    buffer_load_dwordx4 v7, s[12:15], s73 offen lds
    s_add_u32 s73, s73, 16384
    v_exp_f32 v35, v35
    v_exp_f32 v36, v36
    v_cvt_pk_bf16_f32 v65, v34, v35
    v_mfma_f32_32x32x16_bf16 v[16:31], v[80:83], v[76:79], v[48:63]
    v_exp_f32 v37, v37
    s_add_u32 m0, s66, 5120
    s_nop 0
    buffer_load_dwordx4 v7, s[12:15], s74 offen lds
    s_add_u32 s74, s74, 16384
    v_exp_f32 v38, v38
    v_cvt_pk_bf16_f32 v66, v36, v37
    v_exp_f32 v39, v39
    v_exp_f32 v40, v40
    v_cvt_pk_bf16_f32 v67, v38, v39
    v_exp_f32 v41, v41
    v_exp_f32 v42, v42
    v_mfma_f32_32x32x16_bf16 v[112:127], a[56:59], v[64:67], v[112:127]
    v_cvt_pk_bf16_f32 v68, v40, v41
    buffer_load_dwordx4 v[168:171], v2, s[8:11], s72 offen sc1
    s_add_u32 s72, s72, 1024
    v_exp_f32 v43, v43
    v_exp_f32 v44, v44
    v_cvt_pk_bf16_f32 v69, v42, v43
    v_exp_f32 v45, v45
    v_exp_f32 v46, v46
    s_waitcnt vmcnt(6)
    ds_read_b64_tr_b16 v[176:177], v8 offset:0
    ds_read_b64_tr_b16 v[178:179], v8 offset:1024
    ds_read_b64_tr_b16 v[180:181], v9 offset:0
    ds_read_b64_tr_b16 v[182:183], v9 offset:1024
    v_cvt_pk_bf16_f32 v70, v44, v45
    v_exp_f32 v47, v47
    v_exp_f32 v16, v16
    v_cvt_pk_bf16_f32 v71, v46, v47
    s_add_u32 s48, s59, 0
    buffer_load_dwordx4 v[72:75], v2, s[20:23], s48 offen sc1
    v_exp_f32 v17, v17
    s_add_u32 s42, s42, 4096
    v_exp_f32 v18, v18
    v_mfma_f32_32x32x16_bf16 v[112:127], a[60:63], v[68:71], v[112:127]
    v_cvt_pk_bf16_f32 v64, v16, v17
    s_add_u32 m0, s66, 6144
    s_nop 0
    buffer_load_dwordx4 v7, s[12:15], s73 offen lds
    s_add_u32 s73, s73, 16384
    v_exp_f32 v19, v19
    v_exp_f32 v20, v20
    v_cvt_pk_bf16_f32 v65, v18, v19
    v_mfma_f32_32x32x16_bf16 v[32:47], v[84:87], v[76:79], v[48:63]
    v_exp_f32 v21, v21
    s_add_u32 m0, s66, 7168
    s_nop 0
    buffer_load_dwordx4 v7, s[12:15], s74 offen lds
    s_add_u32 s74, s74, 16384
    v_exp_f32 v22, v22
    v_cvt_pk_bf16_f32 v66, v20, v21
    v_exp_f32 v23, v23
    buffer_load_dwordx4 v[80:83], v2, s[20:23], s42 offen offset:0 sc1
    v_exp_f32 v24, v24
    v_cvt_pk_bf16_f32 v67, v22, v23
    v_exp_f32 v25, v25
    ds_write_b128 v6, v[112:115] offset:4608
    ds_write_b128 v6, v[116:119] offset:5632
    ds_write_b32 v0, v120 offset:6656
    v_exp_f32 v26, v26
    v_mfma_f32_32x32x16_bf16 v[112:127], a[0:3], v[64:67], 0
    v_cvt_pk_bf16_f32 v68, v24, v25
    buffer_load_dwordx4 v[172:175], v2, s[8:11], s72 offen sc1
    s_add_u32 s72, s72, 1024
    v_exp_f32 v27, v27
    v_exp_f32 v28, v28
    v_cvt_pk_bf16_f32 v69, v26, v27
    s_waitcnt lgkmcnt(3)
    v_mfma_f32_32x32x16_bf16 v[128:143], v[176:179], v[160:163], v[128:143]
    v_exp_f32 v29, v29
    v_exp_f32 v30, v30
    s_waitcnt vmcnt(8)
    ds_read_b64_tr_b16 v[184:185], v8 offset:2048
    ds_read_b64_tr_b16 v[186:187], v8 offset:3072
    ds_read_b64_tr_b16 v[188:189], v9 offset:2048
    ds_read_b64_tr_b16 v[190:191], v9 offset:3072
    v_cvt_pk_bf16_f32 v70, v28, v29
    v_exp_f32 v31, v31
    v_exp_f32 v32, v32
    v_cvt_pk_bf16_f32 v71, v30, v31
    v_exp_f32 v33, v33
    v_exp_f32 v34, v34
    v_mfma_f32_32x32x16_bf16 v[112:127], a[4:7], v[68:71], v[112:127]
    v_cvt_pk_bf16_f32 v64, v32, v33
    s_add_u32 m0, s66, 0
    s_nop 0
    buffer_load_dwordx4 v7, s[12:15], s73 offen lds
    s_add_u32 s73, s73, 16384
    v_exp_f32 v35, v35
    s_add_u32 s43, s43, 4096
    s_mov_b64 exec, s[62:63]
    buffer_load_dwordx4 a[0:3], v12, s[20:23], s43 offen offset:0 sc1
    buffer_load_dwordx4 a[4:7], v12, s[20:23], s43 offen offset:512 sc1
    s_mov_b64 exec, -1
    v_exp_f32 v36, v36
    v_cvt_pk_bf16_f32 v65, v34, v35
    v_mfma_f32_32x32x16_bf16 v[16:31], v[88:91], v[76:79], v[48:63]
    v_exp_f32 v37, v37
    s_add_u32 m0, s66, 1024
    s_nop 0
    buffer_load_dwordx4 v7, s[12:15], s74 offen lds
    s_add_u32 s74, s74, 16384
    v_exp_f32 v38, v38
    v_cvt_pk_bf16_f32 v66, v36, v37
    v_mfma_f32_32x32x16_bf16 v[144:159], v[180:183], v[160:163], v[144:159]
    v_exp_f32 v39, v39
    buffer_load_dwordx4 v[84:87], v2, s[20:23], s42 offen offset:1024 sc1
    v_exp_f32 v40, v40
    v_cvt_pk_bf16_f32 v67, v38, v39
    v_exp_f32 v41, v41
    v_exp_f32 v42, v42
    v_mfma_f32_32x32x16_bf16 v[112:127], a[8:11], v[64:67], v[112:127]
    v_cvt_pk_bf16_f32 v68, v40, v41
    buffer_load_dwordx4 v[160:163], v2, s[8:11], s72 offen sc1
    s_add_u32 s72, s72, 1024
    v_exp_f32 v43, v43
    v_exp_f32 v44, v44
    v_cvt_pk_bf16_f32 v69, v42, v43
    s_waitcnt lgkmcnt(0)
    v_mfma_f32_32x32x16_bf16 v[128:143], v[184:187], v[164:167], v[128:143]
    v_exp_f32 v45, v45
    v_exp_f32 v46, v46
    v_cvt_pk_bf16_f32 v70, v44, v45
    v_exp_f32 v47, v47
    v_exp_f32 v16, v16
    v_cvt_pk_bf16_f32 v71, v46, v47
    v_exp_f32 v17, v17
    v_exp_f32 v18, v18
    v_mfma_f32_32x32x16_bf16 v[112:127], a[12:15], v[68:71], v[112:127]
    v_cvt_pk_bf16_f32 v64, v16, v17
    v_exp_f32 v19, v19
    s_mov_b64 exec, s[62:63]
    buffer_load_dwordx4 a[8:11], v12, s[20:23], s43 offen offset:1024 sc1
    buffer_load_dwordx4 a[12:15], v12, s[20:23], s43 offen offset:1536 sc1
    s_mov_b64 exec, -1
    v_exp_f32 v20, v20
    v_cvt_pk_bf16_f32 v65, v18, v19
    v_mfma_f32_32x32x16_bf16 v[32:47], v[92:95], v[76:79], v[48:63]
    v_exp_f32 v21, v21
    v_exp_f32 v22, v22
    v_cvt_pk_bf16_f32 v66, v20, v21
    v_exp_f32 v23, v23
    buffer_load_dwordx4 v[88:91], v2, s[20:23], s42 offen offset:2048 sc1
    v_exp_f32 v24, v24
    v_cvt_pk_bf16_f32 v67, v22, v23
    v_exp_f32 v25, v25
    v_exp_f32 v26, v26
    v_mfma_f32_32x32x16_bf16 v[112:127], a[16:19], v[64:67], v[112:127]
    v_cvt_pk_bf16_f32 v68, v24, v25
    v_exp_f32 v27, v27
    v_exp_f32 v28, v28
    v_cvt_pk_bf16_f32 v69, v26, v27
    v_mfma_f32_32x32x16_bf16 v[144:159], v[188:191], v[164:167], v[144:159]
    v_exp_f32 v29, v29
    v_exp_f32 v30, v30
    s_waitcnt vmcnt(14)
    ds_read_b64_tr_b16 v[176:177], v8 offset:4096
    ds_read_b64_tr_b16 v[178:179], v8 offset:5120
    ds_read_b64_tr_b16 v[180:181], v9 offset:4096
    ds_read_b64_tr_b16 v[182:183], v9 offset:5120
    v_cvt_pk_bf16_f32 v70, v28, v29
    v_exp_f32 v31, v31
    v_exp_f32 v32, v32
    v_cvt_pk_bf16_f32 v71, v30, v31
    v_exp_f32 v33, v33
    v_exp_f32 v34, v34
    v_mfma_f32_32x32x16_bf16 v[112:127], a[20:23], v[68:71], v[112:127]
    v_cvt_pk_bf16_f32 v64, v32, v33
    s_add_u32 m0, s66, 2048
    s_nop 0
    buffer_load_dwordx4 v7, s[12:15], s73 offen lds
    s_add_u32 s73, s73, 16384
    v_exp_f32 v35, v35
    s_mov_b64 exec, s[62:63]
    buffer_load_dwordx4 a[16:19], v12, s[20:23], s43 offen offset:2048 sc1
    buffer_load_dwordx4 a[20:23], v12, s[20:23], s43 offen offset:2560 sc1
    s_mov_b64 exec, -1
    v_exp_f32 v36, v36
    v_cvt_pk_bf16_f32 v65, v34, v35
    v_mfma_f32_32x32x16_bf16 v[16:31], v[96:99], v[76:79], v[48:63]
    v_exp_f32 v37, v37
    s_add_u32 m0, s66, 3072
    s_nop 0
    buffer_load_dwordx4 v7, s[12:15], s74 offen lds
    s_add_u32 s74, s74, 16384
    v_exp_f32 v38, v38
    v_cvt_pk_bf16_f32 v66, v36, v37
    v_exp_f32 v39, v39
    buffer_load_dwordx4 v[92:95], v2, s[20:23], s42 offen offset:3072 sc1
    s_add_u32 s42, s42, 4096
    v_exp_f32 v40, v40
    v_cvt_pk_bf16_f32 v67, v38, v39
    v_exp_f32 v41, v41
    v_exp_f32 v42, v42
    v_mfma_f32_32x32x16_bf16 v[112:127], a[24:27], v[64:67], v[112:127]
    v_cvt_pk_bf16_f32 v68, v40, v41
    buffer_load_dwordx4 v[164:167], v2, s[8:11], s72 offen sc1
    s_add_u32 s72, s72, 1024
    v_exp_f32 v43, v43
    v_exp_f32 v44, v44
    v_cvt_pk_bf16_f32 v69, v42, v43
    s_waitcnt lgkmcnt(0)
    v_mfma_f32_32x32x16_bf16 v[128:143], v[176:179], v[168:171], v[128:143]
    v_exp_f32 v45, v45
    v_exp_f32 v46, v46
    v_cvt_pk_bf16_f32 v70, v44, v45
    v_exp_f32 v47, v47
    s_setprio 0
    v_exp_f32 v16, v16
    v_cvt_pk_bf16_f32 v71, v46, v47
    v_exp_f32 v17, v17
    v_exp_f32 v18, v18
    v_mfma_f32_32x32x16_bf16 v[112:127], a[28:31], v[68:71], v[112:127]
    v_cvt_pk_bf16_f32 v64, v16, v17
    v_exp_f32 v19, v19
    s_mov_b64 exec, s[62:63]
    buffer_load_dwordx4 a[24:27], v12, s[20:23], s43 offen offset:3072 sc1
    buffer_load_dwordx4 a[28:31], v12, s[20:23], s43 offen offset:3584 sc1
    s_mov_b64 exec, -1
    v_exp_f32 v20, v20
    v_cvt_pk_bf16_f32 v65, v18, v19
    v_mfma_f32_32x32x16_bf16 v[32:47], v[100:103], v[76:79], v[48:63]
    v_exp_f32 v21, v21
    v_exp_f32 v22, v22
    v_cvt_pk_bf16_f32 v66, v20, v21
    v_exp_f32 v23, v23
    buffer_load_dwordx4 v[96:99], v2, s[20:23], s42 offen offset:0 sc1
    v_exp_f32 v24, v24
    v_cvt_pk_bf16_f32 v67, v22, v23
    v_exp_f32 v25, v25
    v_exp_f32 v26, v26
    v_mfma_f32_32x32x16_bf16 v[112:127], a[32:35], v[64:67], v[112:127]
    v_cvt_pk_bf16_f32 v68, v24, v25
    v_exp_f32 v27, v27
    v_exp_f32 v28, v28
    v_cvt_pk_bf16_f32 v69, v26, v27
    v_mfma_f32_32x32x16_bf16 v[144:159], v[180:183], v[168:171], v[144:159]
    v_exp_f32 v29, v29
    v_exp_f32 v30, v30
    s_waitcnt vmcnt(18)
    ds_read_b64_tr_b16 v[184:185], v8 offset:6144
    ds_read_b64_tr_b16 v[186:187], v8 offset:7168
    ds_read_b64_tr_b16 v[188:189], v9 offset:6144
    ds_read_b64_tr_b16 v[190:191], v9 offset:7168
    v_cvt_pk_bf16_f32 v70, v28, v29
    v_exp_f32 v31, v31
    v_exp_f32 v32, v32
    v_cvt_pk_bf16_f32 v71, v30, v31
    v_exp_f32 v33, v33
    v_exp_f32 v34, v34
    v_mfma_f32_32x32x16_bf16 v[112:127], a[36:39], v[68:71], v[112:127]
    v_cvt_pk_bf16_f32 v64, v32, v33
    s_add_u32 m0, s66, 4096
    s_nop 0
    buffer_load_dwordx4 v7, s[12:15], s73 offen lds
    s_add_u32 s73, s73, 16384
    v_exp_f32 v35, v35
    s_add_u32 s43, s43, 4096
    s_mov_b64 exec, s[62:63]
    buffer_load_dwordx4 a[32:35], v12, s[20:23], s43 offen offset:0 sc1
    buffer_load_dwordx4 a[36:39], v12, s[20:23], s43 offen offset:512 sc1
    s_mov_b64 exec, -1
    v_exp_f32 v36, v36
    v_cvt_pk_bf16_f32 v65, v34, v35
    v_mfma_f32_32x32x16_bf16 v[16:31], v[104:107], v[76:79], v[48:63]
    v_exp_f32 v37, v37
    s_add_u32 m0, s66, 5120
    s_nop 0
    buffer_load_dwordx4 v7, s[12:15], s74 offen lds
    s_add_u32 s74, s74, 16384
    v_exp_f32 v38, v38
    v_cvt_pk_bf16_f32 v66, v36, v37
    v_exp_f32 v39, v39
    buffer_load_dwordx4 v[100:103], v2, s[20:23], s42 offen offset:1024 sc1
    v_exp_f32 v40, v40
    v_cvt_pk_bf16_f32 v67, v38, v39
    v_exp_f32 v41, v41
    v_exp_f32 v42, v42
    v_mfma_f32_32x32x16_bf16 v[112:127], a[40:43], v[64:67], v[112:127]
    v_cvt_pk_bf16_f32 v68, v40, v41
    buffer_load_dwordx4 v[168:171], v2, s[8:11], s72 offen sc1
    s_add_u32 s72, s72, 1024
    v_exp_f32 v43, v43
    v_exp_f32 v44, v44
    v_cvt_pk_bf16_f32 v69, v42, v43
    s_waitcnt lgkmcnt(0)
    v_mfma_f32_32x32x16_bf16 v[128:143], v[184:187], v[172:175], v[128:143]
    v_exp_f32 v45, v45
    v_exp_f32 v46, v46
    v_cvt_pk_bf16_f32 v70, v44, v45
    v_exp_f32 v47, v47
    v_exp_f32 v16, v16
    v_cvt_pk_bf16_f32 v71, v46, v47
    v_exp_f32 v17, v17
    v_exp_f32 v18, v18
    v_mfma_f32_32x32x16_bf16 v[112:127], a[44:47], v[68:71], v[112:127]
    v_cvt_pk_bf16_f32 v64, v16, v17
    v_exp_f32 v19, v19
    s_mov_b64 exec, s[62:63]
    buffer_load_dwordx4 a[40:43], v12, s[20:23], s43 offen offset:1024 sc1
    buffer_load_dwordx4 a[44:47], v12, s[20:23], s43 offen offset:1536 sc1
    s_mov_b64 exec, -1
    v_exp_f32 v20, v20
    v_cvt_pk_bf16_f32 v65, v18, v19
    v_mfma_f32_32x32x16_bf16 v[32:47], v[108:111], v[76:79], v[48:63]
    v_exp_f32 v21, v21
    v_exp_f32 v22, v22
    v_cvt_pk_bf16_f32 v66, v20, v21
    v_exp_f32 v23, v23
    buffer_load_dwordx4 v[104:107], v2, s[20:23], s42 offen offset:2048 sc1
    v_exp_f32 v24, v24
    v_cvt_pk_bf16_f32 v67, v22, v23
    v_exp_f32 v25, v25
    v_exp_f32 v26, v26
    v_mfma_f32_32x32x16_bf16 v[112:127], a[48:51], v[64:67], v[112:127]
    v_cvt_pk_bf16_f32 v68, v24, v25
    v_exp_f32 v27, v27
    v_exp_f32 v28, v28
    v_cvt_pk_bf16_f32 v69, v26, v27
    v_mfma_f32_32x32x16_bf16 v[144:159], v[188:191], v[172:175], v[144:159]
    v_exp_f32 v29, v29
    v_exp_f32 v30, v30
    s_waitcnt vmcnt(21)
    ds_read_b64_tr_b16 v[176:177], v8 offset:0
    ds_read_b64_tr_b16 v[178:179], v8 offset:1024
    ds_read_b64_tr_b16 v[180:181], v9 offset:0
    ds_read_b64_tr_b16 v[182:183], v9 offset:1024
    v_cvt_pk_bf16_f32 v70, v28, v29
    v_exp_f32 v31, v31
    s_cmp_eq_u32 s60, 0
    s_cbranch_scc1 SLOWC_I3
    ds_read_b32 v16, v13 offset:0
    ds_read_b32 v17, v13 offset:1024
    ds_read_b32 v18, v13 offset:2048
    ds_read_b32 v19, v13 offset:3072
    s_waitcnt lgkmcnt(0)
    v_max_f32 v16, v16, v17
    v_max_f32 v16, v16, v18
    v_max_f32 v16, v16, v19
    v_sub_f32 v16, 0, v16
    s_nop 7
    v_mov_b32 v48, v16
    v_mov_b32 v49, v16
    v_mov_b32 v50, v16
    v_mov_b32 v51, v16
    v_mov_b32 v52, v16
    v_mov_b32 v53, v16
    v_mov_b32 v54, v16
    v_mov_b32 v55, v16
    v_mov_b32 v56, v16
    v_mov_b32 v57, v16
    v_mov_b32 v58, v16
    v_mov_b32 v59, v16
    v_mov_b32 v60, v16
    v_mov_b32 v61, v16
    v_mov_b32 v62, v16
    v_mov_b32 v63, v16
    s_nop 1
SLOWC_I3:
    v_exp_f32 v32, v32
    s_waitcnt vmcnt(31)
    v_cvt_pk_bf16_f32 v71, v30, v31
    v_exp_f32 v33, v33
    v_exp_f32 v34, v34
    v_mfma_f32_32x32x16_bf16 v[112:127], a[52:55], v[68:71], v[112:127]
    v_cvt_pk_bf16_f32 v64, v32, v33
    s_add_u32 m0, s66, 6144
    s_nop 0
    buffer_load_dwordx4 v7, s[12:15], s73 offen lds
    s_add_u32 s73, s73, 16384
    v_exp_f32 v35, v35
    s_mov_b64 exec, s[62:63]
    buffer_load_dwordx4 a[48:51], v12, s[20:23], s43 offen offset:2048 sc1
    buffer_load_dwordx4 a[52:55], v12, s[20:23], s43 offen offset:2560 sc1
    s_mov_b64 exec, -1
    v_exp_f32 v36, v36
    s_waitcnt vmcnt(31)
    v_cvt_pk_bf16_f32 v65, v34, v35
    v_mfma_f32_32x32x16_bf16 v[16:31], v[80:83], v[72:75], v[48:63]
    v_exp_f32 v37, v37
    s_add_u32 m0, s66, 7168
    s_nop 0
    buffer_load_dwordx4 v7, s[12:15], s74 offen lds
    s_add_u32 s74, s74, 16384
    v_exp_f32 v38, v38
    v_cvt_pk_bf16_f32 v66, v36, v37
    v_exp_f32 v39, v39
    buffer_load_dwordx4 v[108:111], v2, s[20:23], s42 offen offset:3072 sc1
    v_exp_f32 v40, v40
    v_cvt_pk_bf16_f32 v67, v38, v39
    v_exp_f32 v41, v41
    v_exp_f32 v42, v42
    v_mfma_f32_32x32x16_bf16 v[112:127], a[56:59], v[64:67], v[112:127]
    v_cvt_pk_bf16_f32 v68, v40, v41
    buffer_load_dwordx4 v[172:175], v2, s[8:11], s72 offen sc1
    s_add_u32 s72, s72, 1024
    v_exp_f32 v43, v43
    v_exp_f32 v44, v44
    v_cvt_pk_bf16_f32 v69, v42, v43
    s_waitcnt lgkmcnt(0)
    v_mfma_f32_32x32x16_bf16 v[128:143], v[176:179], v[160:163], v[128:143]
    v_exp_f32 v45, v45
    v_exp_f32 v46, v46
    v_cvt_pk_bf16_f32 v70, v44, v45
    v_exp_f32 v47, v47
    v_exp_f32 v16, v16
    v_cvt_pk_bf16_f32 v71, v46, v47
    s_add_u32 s48, s59, 1024
    buffer_load_dwordx4 v[76:79], v2, s[20:23], s48 offen sc1
    v_exp_f32 v17, v17
    v_exp_f32 v18, v18
    v_mfma_f32_32x32x16_bf16 v[112:127], a[60:63], v[68:71], v[112:127]
    v_cvt_pk_bf16_f32 v64, v16, v17
    v_exp_f32 v19, v19
    s_mov_b64 exec, s[62:63]
    buffer_load_dwordx4 a[56:59], v12, s[20:23], s43 offen offset:3072 sc1
    buffer_load_dwordx4 a[60:63], v12, s[20:23], s43 offen offset:3584 sc1
    s_mov_b64 exec, -1
    v_exp_f32 v20, v20
    s_waitcnt vmcnt(31)
    v_cvt_pk_bf16_f32 v65, v18, v19
    v_mfma_f32_32x32x16_bf16 v[32:47], v[84:87], v[72:75], v[48:63]
    v_exp_f32 v21, v21
    v_exp_f32 v22, v22
    v_cvt_pk_bf16_f32 v66, v20, v21
    v_exp_f32 v23, v23
    v_exp_f32 v24, v24
    v_cvt_pk_bf16_f32 v67, v22, v23
    s_waitcnt vmcnt(33)
    v_exp_f32 v25, v25
    ds_write_b128 v6, v[112:115] offset:6912
    ds_write_b128 v6, v[116:119] offset:7936
    ds_write_b32 v0, v120 offset:8960
    ds_read_b128 v[112:115], v6 offset:0
    ds_read_b128 v[116:119], v6 offset:1024
    ds_read_b32 v120, v0 offset:2048
    v_exp_f32 v26, v26
    v_cvt_pk_bf16_f32 v68, v24, v25
    v_exp_f32 v27, v27
    v_exp_f32 v28, v28
    v_cvt_pk_bf16_f32 v69, v26, v27
    v_mfma_f32_32x32x16_bf16 v[144:159], v[180:183], v[160:163], v[144:159]
    v_exp_f32 v29, v29
    v_exp_f32 v30, v30
    s_waitcnt vmcnt(21)
    ds_read_b64_tr_b16 v[184:185], v8 offset:2048
    ds_read_b64_tr_b16 v[186:187], v8 offset:3072
    ds_read_b64_tr_b16 v[188:189], v9 offset:2048
    ds_read_b64_tr_b16 v[190:191], v9 offset:3072
    v_cvt_pk_bf16_f32 v70, v28, v29
    v_exp_f32 v31, v31
    s_waitcnt lgkmcnt(4)
    v_mfma_f32_32x32x16_bf16 v[112:127], a[0:3], v[64:67], v[112:127]
    v_exp_f32 v32, v32
    v_cvt_pk_bf16_f32 v71, v30, v31
    v_exp_f32 v33, v33
    v_exp_f32 v34, v34
    v_mfma_f32_32x32x16_bf16 v[112:127], a[4:7], v[68:71], v[112:127]
    v_cvt_pk_bf16_f32 v64, v32, v33
    s_add_u32 m0, s66, 0
    s_nop 0
    buffer_load_dwordx4 v7, s[12:15], s73 offen lds
    s_add_u32 s73, s73, 16384
    v_exp_f32 v35, v35
    v_exp_f32 v36, v36
    s_waitcnt vmcnt(28)
    v_cvt_pk_bf16_f32 v65, v34, v35
    v_mfma_f32_32x32x16_bf16 v[16:31], v[88:91], v[72:75], v[48:63]
    v_exp_f32 v37, v37
    s_add_u32 m0, s66, 1024
    s_nop 0
    buffer_load_dwordx4 v7, s[12:15], s74 offen lds
    s_add_u32 s74, s74, 16384
    v_exp_f32 v38, v38
    v_cvt_pk_bf16_f32 v66, v36, v37
    v_exp_f32 v39, v39
    v_exp_f32 v40, v40
    v_cvt_pk_bf16_f32 v67, v38, v39
    s_waitcnt vmcnt(30)
    v_exp_f32 v41, v41
    v_exp_f32 v42, v42
    v_mfma_f32_32x32x16_bf16 v[112:127], a[8:11], v[64:67], v[112:127]
    v_cvt_pk_bf16_f32 v68, v40, v41
    buffer_load_dwordx4 v[160:163], v2, s[8:11], s72 offen sc1
    s_add_u32 s72, s72, 1024
    v_exp_f32 v43, v43
    v_exp_f32 v44, v44
    v_cvt_pk_bf16_f32 v69, v42, v43
    s_waitcnt lgkmcnt(0)
    v_mfma_f32_32x32x16_bf16 v[128:143], v[184:187], v[164:167], v[128:143]
    v_exp_f32 v45, v45
    v_exp_f32 v46, v46
    s_waitcnt vmcnt(15)
    ds_read_b64_tr_b16 v[176:177], v8 offset:4096
    ds_read_b64_tr_b16 v[178:179], v8 offset:5120
    ds_read_b64_tr_b16 v[180:181], v9 offset:4096
    ds_read_b64_tr_b16 v[182:183], v9 offset:5120
    v_cvt_pk_bf16_f32 v70, v44, v45
    v_exp_f32 v47, v47
    v_exp_f32 v16, v16
    v_cvt_pk_bf16_f32 v71, v46, v47
    v_exp_f32 v17, v17
    v_exp_f32 v18, v18
    v_mfma_f32_32x32x16_bf16 v[112:127], a[12:15], v[68:71], v[112:127]
    v_cvt_pk_bf16_f32 v64, v16, v17
    s_add_u32 m0, s66, 2048
    s_nop 0
    buffer_load_dwordx4 v7, s[12:15], s73 offen lds
    s_add_u32 s73, s73, 16384
    v_exp_f32 v19, v19
    v_exp_f32 v20, v20
    s_waitcnt vmcnt(26)
    v_cvt_pk_bf16_f32 v65, v18, v19
    v_mfma_f32_32x32x16_bf16 v[32:47], v[92:95], v[72:75], v[48:63]
    v_exp_f32 v21, v21
    s_add_u32 m0, s66, 3072
    s_nop 0
    buffer_load_dwordx4 v7, s[12:15], s74 offen lds
    s_add_u32 s74, s74, 16384
    v_exp_f32 v22, v22
    v_cvt_pk_bf16_f32 v66, v20, v21
    v_mfma_f32_32x32x16_bf16 v[144:159], v[188:191], v[164:167], v[144:159]
    v_exp_f32 v23, v23
    v_exp_f32 v24, v24
    v_cvt_pk_bf16_f32 v67, v22, v23
    s_waitcnt vmcnt(29)
    v_exp_f32 v25, v25
    v_exp_f32 v26, v26
    v_mfma_f32_32x32x16_bf16 v[112:127], a[16:19], v[64:67], v[112:127]
    v_cvt_pk_bf16_f32 v68, v24, v25
    buffer_load_dwordx4 v[164:167], v2, s[8:11], s72 offen sc1
    s_add_u32 s72, s72, 1024
    v_exp_f32 v27, v27
    v_exp_f32 v28, v28
    v_cvt_pk_bf16_f32 v69, v26, v27
    s_waitcnt lgkmcnt(0)
    v_mfma_f32_32x32x16_bf16 v[128:143], v[176:179], v[168:171], v[128:143]
    v_exp_f32 v29, v29
    v_exp_f32 v30, v30
    v_cvt_pk_bf16_f32 v70, v28, v29
    v_exp_f32 v31, v31
    v_exp_f32 v32, v32
    v_cvt_pk_bf16_f32 v71, v30, v31
    v_exp_f32 v33, v33
    v_exp_f32 v34, v34
    v_mfma_f32_32x32x16_bf16 v[112:127], a[20:23], v[68:71], v[112:127]
    v_cvt_pk_bf16_f32 v64, v32, v33
    v_exp_f32 v35, v35
    v_exp_f32 v36, v36
    s_waitcnt vmcnt(24)
    v_cvt_pk_bf16_f32 v65, v34, v35
    v_mfma_f32_32x32x16_bf16 v[16:31], v[96:99], v[72:75], v[48:63]
    v_exp_f32 v37, v37
    v_exp_f32 v38, v38
    v_cvt_pk_bf16_f32 v66, v36, v37
    v_exp_f32 v39, v39
    v_exp_f32 v40, v40
    v_cvt_pk_bf16_f32 v67, v38, v39
    s_waitcnt vmcnt(25)
    v_exp_f32 v41, v41
    v_exp_f32 v42, v42
    v_mfma_f32_32x32x16_bf16 v[112:127], a[24:27], v[64:67], v[112:127]
    v_cvt_pk_bf16_f32 v68, v40, v41
    v_exp_f32 v43, v43
    v_exp_f32 v44, v44
    v_cvt_pk_bf16_f32 v69, v42, v43
    v_mfma_f32_32x32x16_bf16 v[144:159], v[180:183], v[168:171], v[144:159]
    v_exp_f32 v45, v45
    v_exp_f32 v46, v46
    s_waitcnt vmcnt(9)
    ds_read_b64_tr_b16 v[184:185], v8 offset:6144
    ds_read_b64_tr_b16 v[186:187], v8 offset:7168
    ds_read_b64_tr_b16 v[188:189], v9 offset:6144
    ds_read_b64_tr_b16 v[190:191], v9 offset:7168
    v_cvt_pk_bf16_f32 v70, v44, v45
    v_exp_f32 v47, v47
    v_exp_f32 v16, v16
    v_cvt_pk_bf16_f32 v71, v46, v47
    v_exp_f32 v17, v17
    v_exp_f32 v18, v18
    v_mfma_f32_32x32x16_bf16 v[112:127], a[28:31], v[68:71], v[112:127]
    v_cvt_pk_bf16_f32 v64, v16, v17
    s_add_u32 m0, s66, 4096
    s_nop 0
    buffer_load_dwordx4 v7, s[12:15], s73 offen lds
    s_add_u32 s73, s73, 16384
    v_exp_f32 v19, v19
    v_exp_f32 v20, v20
    s_waitcnt vmcnt(20)
    v_cvt_pk_bf16_f32 v65, v18, v19
    v_mfma_f32_32x32x16_bf16 v[32:47], v[100:103], v[72:75], v[48:63]
    v_exp_f32 v21, v21
    s_add_u32 m0, s66, 5120
    s_nop 0
    buffer_load_dwordx4 v7, s[12:15], s74 offen lds
    s_add_u32 s74, s74, 16384
    v_exp_f32 v22, v22
    v_cvt_pk_bf16_f32 v66, v20, v21
    v_exp_f32 v23, v23
    v_exp_f32 v24, v24
    v_cvt_pk_bf16_f32 v67, v22, v23
    s_waitcnt vmcnt(23)
    v_exp_f32 v25, v25
    v_exp_f32 v26, v26
    v_mfma_f32_32x32x16_bf16 v[112:127], a[32:35], v[64:67], v[112:127]
    v_cvt_pk_bf16_f32 v68, v24, v25
    buffer_load_dwordx4 v[168:171], v2, s[8:11], s72 offen sc1
    s_add_u32 s72, s72, 1024
    v_exp_f32 v27, v27
    v_exp_f32 v28, v28
    v_cvt_pk_bf16_f32 v69, v26, v27
    s_waitcnt lgkmcnt(0)
    v_mfma_f32_32x32x16_bf16 v[128:143], v[184:187], v[172:175], v[128:143]
    v_exp_f32 v29, v29
    v_exp_f32 v30, v30
    v_cvt_pk_bf16_f32 v70, v28, v29
    v_exp_f32 v31, v31
    v_exp_f32 v32, v32
    v_cvt_pk_bf16_f32 v71, v30, v31
    v_exp_f32 v33, v33
    v_exp_f32 v34, v34
    v_mfma_f32_32x32x16_bf16 v[112:127], a[36:39], v[68:71], v[112:127]
    v_cvt_pk_bf16_f32 v64, v32, v33
    v_exp_f32 v35, v35
    v_exp_f32 v36, v36
    s_waitcnt vmcnt(18)
    v_cvt_pk_bf16_f32 v65, v34, v35
    v_mfma_f32_32x32x16_bf16 v[16:31], v[104:107], v[72:75], v[48:63]
    v_exp_f32 v37, v37
    v_exp_f32 v38, v38
    v_cvt_pk_bf16_f32 v66, v36, v37
    v_exp_f32 v39, v39
    v_exp_f32 v40, v40
    v_cvt_pk_bf16_f32 v67, v38, v39
    s_waitcnt vmcnt(19)
    v_exp_f32 v41, v41
    v_exp_f32 v42, v42
    v_mfma_f32_32x32x16_bf16 v[112:127], a[40:43], v[64:67], v[112:127]
    v_cvt_pk_bf16_f32 v68, v40, v41
    v_exp_f32 v43, v43
    v_exp_f32 v44, v44
    v_cvt_pk_bf16_f32 v69, v42, v43
    v_mfma_f32_32x32x16_bf16 v[144:159], v[188:191], v[172:175], v[144:159]
    v_exp_f32 v45, v45
    v_exp_f32 v46, v46
    s_waitcnt vmcnt(6)
    ds_read_b64_tr_b16 v[176:177], v8 offset:0
    ds_read_b64_tr_b16 v[178:179], v8 offset:1024
    ds_read_b64_tr_b16 v[180:181], v9 offset:0
    ds_read_b64_tr_b16 v[182:183], v9 offset:1024
    v_cvt_pk_bf16_f32 v70, v44, v45
    v_exp_f32 v47, v47
    v_exp_f32 v16, v16
    v_cvt_pk_bf16_f32 v71, v46, v47
    v_exp_f32 v17, v17
    v_exp_f32 v18, v18
    v_mfma_f32_32x32x16_bf16 v[112:127], a[44:47], v[68:71], v[112:127]
    v_cvt_pk_bf16_f32 v64, v16, v17
    s_add_u32 m0, s66, 6144
    s_nop 0
    buffer_load_dwordx4 v7, s[12:15], s73 offen lds
    s_add_u32 s73, s73, 16384
    v_exp_f32 v19, v19
    v_exp_f32 v20, v20
    s_waitcnt vmcnt(14)
    v_cvt_pk_bf16_f32 v65, v18, v19
    v_mfma_f32_32x32x16_bf16 v[32:47], v[108:111], v[72:75], v[48:63]
    v_exp_f32 v21, v21
    s_add_u32 m0, s66, 7168
    s_nop 0
    buffer_load_dwordx4 v7, s[12:15], s74 offen lds
    s_add_u32 s74, s74, 16384
    v_exp_f32 v22, v22
    v_cvt_pk_bf16_f32 v66, v20, v21
    v_exp_f32 v23, v23
    v_exp_f32 v24, v24
    v_cvt_pk_bf16_f32 v67, v22, v23
    s_waitcnt vmcnt(17)
    v_exp_f32 v25, v25
    v_exp_f32 v26, v26
    v_mfma_f32_32x32x16_bf16 v[112:127], a[48:51], v[64:67], v[112:127]
    v_cvt_pk_bf16_f32 v68, v24, v25
    buffer_load_dwordx4 v[172:175], v2, s[8:11], s72 offen sc1
    s_add_u32 s72, s72, 1024
    v_exp_f32 v27, v27
    v_exp_f32 v28, v28
    v_cvt_pk_bf16_f32 v69, v26, v27
    s_waitcnt lgkmcnt(0)
    v_mfma_f32_32x32x16_bf16 v[128:143], v[176:179], v[160:163], v[128:143]
    v_exp_f32 v29, v29
    v_exp_f32 v30, v30
    v_cvt_pk_bf16_f32 v70, v28, v29
    v_exp_f32 v31, v31
    s_cmp_eq_u32 s60, 0
    s_cbranch_scc1 SLOWC_I4
    ds_read_b32 v16, v13 offset:128
    ds_read_b32 v17, v13 offset:1152
    ds_read_b32 v18, v13 offset:2176
    ds_read_b32 v19, v13 offset:3200
    s_waitcnt lgkmcnt(0)
    v_max_f32 v16, v16, v17
    v_max_f32 v16, v16, v18
    v_max_f32 v16, v16, v19
    v_sub_f32 v16, 0, v16
    s_nop 7
    v_mov_b32 v48, v16
    v_mov_b32 v49, v16
    v_mov_b32 v50, v16
    v_mov_b32 v51, v16
    v_mov_b32 v52, v16
    v_mov_b32 v53, v16
    v_mov_b32 v54, v16
    v_mov_b32 v55, v16
    v_mov_b32 v56, v16
    v_mov_b32 v57, v16
    v_mov_b32 v58, v16
    v_mov_b32 v59, v16
    v_mov_b32 v60, v16
    v_mov_b32 v61, v16
    v_mov_b32 v62, v16
    v_mov_b32 v63, v16
    s_nop 1
SLOWC_I4:
    v_exp_f32 v32, v32
    s_waitcnt vmcnt(14)
    v_cvt_pk_bf16_f32 v71, v30, v31
    v_exp_f32 v33, v33
    v_exp_f32 v34, v34
    v_mfma_f32_32x32x16_bf16 v[112:127], a[52:55], v[68:71], v[112:127]
    v_cvt_pk_bf16_f32 v64, v32, v33
    v_exp_f32 v35, v35
    v_exp_f32 v36, v36
    v_cvt_pk_bf16_f32 v65, v34, v35
    v_mfma_f32_32x32x16_bf16 v[16:31], v[80:83], v[76:79], v[48:63]
    v_exp_f32 v37, v37
    v_exp_f32 v38, v38
    v_cvt_pk_bf16_f32 v66, v36, v37
    v_exp_f32 v39, v39
    v_exp_f32 v40, v40
    v_cvt_pk_bf16_f32 v67, v38, v39
    s_waitcnt vmcnt(12)
    v_exp_f32 v41, v41
    v_exp_f32 v42, v42
    v_mfma_f32_32x32x16_bf16 v[112:127], a[56:59], v[64:67], v[112:127]
    v_cvt_pk_bf16_f32 v68, v40, v41
    v_exp_f32 v43, v43
    v_exp_f32 v44, v44
    v_cvt_pk_bf16_f32 v69, v42, v43
    v_mfma_f32_32x32x16_bf16 v[144:159], v[180:183], v[160:163], v[144:159]
    v_exp_f32 v45, v45
    v_exp_f32 v46, v46
    s_waitcnt vmcnt(6)
    ds_read_b64_tr_b16 v[184:185], v8 offset:2048
    ds_read_b64_tr_b16 v[186:187], v8 offset:3072
    ds_read_b64_tr_b16 v[188:189], v9 offset:2048
    ds_read_b64_tr_b16 v[190:191], v9 offset:3072
    v_cvt_pk_bf16_f32 v70, v44, v45
    v_exp_f32 v47, v47
    v_exp_f32 v16, v16
    v_cvt_pk_bf16_f32 v71, v46, v47
    s_add_u32 s48, s59, 2048
    buffer_load_dwordx4 v[72:75], v2, s[20:23], s48 offen sc1
    v_exp_f32 v17, v17
    v_exp_f32 v18, v18
    v_mfma_f32_32x32x16_bf16 v[112:127], a[60:63], v[68:71], v[112:127]
    v_cvt_pk_bf16_f32 v64, v16, v17
    s_add_u32 m0, s66, 0
    s_nop 0
    buffer_load_dwordx4 v7, s[12:15], s73 offen lds
    s_add_u32 s73, s73, 16384
    v_exp_f32 v19, v19
    v_exp_f32 v20, v20
    v_cvt_pk_bf16_f32 v65, v18, v19
    v_mfma_f32_32x32x16_bf16 v[32:47], v[84:87], v[76:79], v[48:63]
    v_exp_f32 v21, v21
    s_add_u32 m0, s66, 1024
    s_nop 0
    buffer_load_dwordx4 v7, s[12:15], s74 offen lds
    s_add_u32 s74, s74, 16384
    v_exp_f32 v22, v22
    v_cvt_pk_bf16_f32 v66, v20, v21
    v_exp_f32 v23, v23
    v_exp_f32 v24, v24
    v_cvt_pk_bf16_f32 v67, v22, v23
    v_exp_f32 v25, v25
    ds_write_b128 v6, v[112:115] offset:0
    ds_write_b128 v6, v[116:119] offset:1024
    ds_write_b32 v0, v120 offset:2048
    ds_read_b128 v[112:115], v6 offset:2304
    ds_read_b128 v[116:119], v6 offset:3328
    ds_read_b32 v120, v0 offset:4352
    v_exp_f32 v26, v26
    v_cvt_pk_bf16_f32 v68, v24, v25
    buffer_load_dwordx4 v[160:163], v2, s[8:11], s72 offen sc1
    s_add_u32 s72, s72, 1024
    v_exp_f32 v27, v27
    v_exp_f32 v28, v28
    v_cvt_pk_bf16_f32 v69, v26, v27
    s_waitcnt lgkmcnt(6)
    v_mfma_f32_32x32x16_bf16 v[128:143], v[184:187], v[164:167], v[128:143]
    v_exp_f32 v29, v29
    v_exp_f32 v30, v30
    v_cvt_pk_bf16_f32 v70, v28, v29
    v_exp_f32 v31, v31
    s_waitcnt lgkmcnt(0)
    v_mfma_f32_32x32x16_bf16 v[112:127], a[0:3], v[64:67], v[112:127]
    v_exp_f32 v32, v32
    v_cvt_pk_bf16_f32 v71, v30, v31
    v_exp_f32 v33, v33
    v_exp_f32 v34, v34
    v_mfma_f32_32x32x16_bf16 v[112:127], a[4:7], v[68:71], v[112:127]
    v_cvt_pk_bf16_f32 v64, v32, v33
    v_exp_f32 v35, v35
    v_exp_f32 v36, v36
    v_cvt_pk_bf16_f32 v65, v34, v35
    v_mfma_f32_32x32x16_bf16 v[16:31], v[88:91], v[76:79], v[48:63]
    v_exp_f32 v37, v37
    v_exp_f32 v38, v38
    v_cvt_pk_bf16_f32 v66, v36, v37
    v_exp_f32 v39, v39
    v_exp_f32 v40, v40
    v_cvt_pk_bf16_f32 v67, v38, v39
    v_exp_f32 v41, v41
    v_exp_f32 v42, v42
    v_mfma_f32_32x32x16_bf16 v[112:127], a[8:11], v[64:67], v[112:127]
    v_cvt_pk_bf16_f32 v68, v40, v41
    v_exp_f32 v43, v43
    v_exp_f32 v44, v44
    v_cvt_pk_bf16_f32 v69, v42, v43
    v_mfma_f32_32x32x16_bf16 v[144:159], v[188:191], v[164:167], v[144:159]
    v_exp_f32 v45, v45
    v_exp_f32 v46, v46
    s_waitcnt vmcnt(7)
    ds_read_b64_tr_b16 v[176:177], v8 offset:4096
    ds_read_b64_tr_b16 v[178:179], v8 offset:5120
    ds_read_b64_tr_b16 v[180:181], v9 offset:4096
    ds_read_b64_tr_b16 v[182:183], v9 offset:5120
    v_cvt_pk_bf16_f32 v70, v44, v45
    v_exp_f32 v47, v47
    v_exp_f32 v16, v16
    v_cvt_pk_bf16_f32 v71, v46, v47
    v_exp_f32 v17, v17
    v_exp_f32 v18, v18
    v_mfma_f32_32x32x16_bf16 v[112:127], a[12:15], v[68:71], v[112:127]
    v_cvt_pk_bf16_f32 v64, v16, v17
    s_add_u32 m0, s66, 2048
    s_nop 0
    buffer_load_dwordx4 v7, s[12:15], s73 offen lds
    s_add_u32 s73, s73, 16384
    v_exp_f32 v19, v19
    v_exp_f32 v20, v20
    v_cvt_pk_bf16_f32 v65, v18, v19
    v_mfma_f32_32x32x16_bf16 v[32:47], v[92:95], v[76:79], v[48:63]
    v_exp_f32 v21, v21
    s_add_u32 m0, s66, 3072
    s_nop 0
    buffer_load_dwordx4 v7, s[12:15], s74 offen lds
    s_add_u32 s74, s74, 16384
    v_exp_f32 v22, v22
    v_cvt_pk_bf16_f32 v66, v20, v21
    v_exp_f32 v23, v23
    v_exp_f32 v24, v24
    v_cvt_pk_bf16_f32 v67, v22, v23
    v_exp_f32 v25, v25
    v_exp_f32 v26, v26
    v_mfma_f32_32x32x16_bf16 v[112:127], a[16:19], v[64:67], v[112:127]
    v_cvt_pk_bf16_f32 v68, v24, v25
    buffer_load_dwordx4 v[164:167], v2, s[8:11], s72 offen sc1
    s_add_u32 s72, s72, 1024
    v_exp_f32 v27, v27
    v_exp_f32 v28, v28
    v_cvt_pk_bf16_f32 v69, v26, v27
    s_waitcnt lgkmcnt(0)
    v_mfma_f32_32x32x16_bf16 v[128:143], v[176:179], v[168:171], v[128:143]
    v_exp_f32 v29, v29
    v_exp_f32 v30, v30
    v_cvt_pk_bf16_f32 v70, v28, v29
    v_exp_f32 v31, v31
    v_exp_f32 v32, v32
    v_cvt_pk_bf16_f32 v71, v30, v31
    v_exp_f32 v33, v33
    v_exp_f32 v34, v34
    v_mfma_f32_32x32x16_bf16 v[112:127], a[20:23], v[68:71], v[112:127]
    v_cvt_pk_bf16_f32 v64, v32, v33
    v_exp_f32 v35, v35
    v_exp_f32 v36, v36
    v_cvt_pk_bf16_f32 v65, v34, v35
    v_mfma_f32_32x32x16_bf16 v[16:31], v[96:99], v[76:79], v[48:63]
    v_exp_f32 v37, v37
    v_exp_f32 v38, v38
    v_cvt_pk_bf16_f32 v66, v36, v37
    v_exp_f32 v39, v39
    v_exp_f32 v40, v40
    v_cvt_pk_bf16_f32 v67, v38, v39
    v_exp_f32 v41, v41
    v_exp_f32 v42, v42
    v_mfma_f32_32x32x16_bf16 v[112:127], a[24:27], v[64:67], v[112:127]
    v_cvt_pk_bf16_f32 v68, v40, v41
    v_exp_f32 v43, v43
    v_exp_f32 v44, v44
    v_cvt_pk_bf16_f32 v69, v42, v43
    v_mfma_f32_32x32x16_bf16 v[144:159], v[180:183], v[168:171], v[144:159]
    v_exp_f32 v45, v45
    v_exp_f32 v46, v46
    s_waitcnt vmcnt(7)
    ds_read_b64_tr_b16 v[184:185], v8 offset:6144
    ds_read_b64_tr_b16 v[186:187], v8 offset:7168
    ds_read_b64_tr_b16 v[188:189], v9 offset:6144
    ds_read_b64_tr_b16 v[190:191], v9 offset:7168
    v_cvt_pk_bf16_f32 v70, v44, v45
    v_exp_f32 v47, v47
    v_exp_f32 v16, v16
    v_cvt_pk_bf16_f32 v71, v46, v47
    v_exp_f32 v17, v17
    v_exp_f32 v18, v18
    v_mfma_f32_32x32x16_bf16 v[112:127], a[28:31], v[68:71], v[112:127]
    v_cvt_pk_bf16_f32 v64, v16, v17
    s_add_u32 m0, s66, 4096
    s_nop 0
    buffer_load_dwordx4 v7, s[12:15], s73 offen lds
    s_add_u32 s73, s73, 16384
    v_exp_f32 v19, v19
    v_exp_f32 v20, v20
    v_cvt_pk_bf16_f32 v65, v18, v19
    v_mfma_f32_32x32x16_bf16 v[32:47], v[100:103], v[76:79], v[48:63]
    v_exp_f32 v21, v21
    s_add_u32 m0, s66, 5120
    s_nop 0
    buffer_load_dwordx4 v7, s[12:15], s74 offen lds
    s_add_u32 s74, s74, 16384
    v_exp_f32 v22, v22
    v_cvt_pk_bf16_f32 v66, v20, v21
    v_exp_f32 v23, v23
    v_exp_f32 v24, v24
    v_cvt_pk_bf16_f32 v67, v22, v23
    v_exp_f32 v25, v25
    v_exp_f32 v26, v26
    v_mfma_f32_32x32x16_bf16 v[112:127], a[32:35], v[64:67], v[112:127]
    v_cvt_pk_bf16_f32 v68, v24, v25
    buffer_load_dwordx4 v[168:171], v2, s[8:11], s72 offen sc1
    s_add_u32 s72, s72, 1024
    v_exp_f32 v27, v27
    v_exp_f32 v28, v28
    v_cvt_pk_bf16_f32 v69, v26, v27
    s_waitcnt lgkmcnt(0)
    v_mfma_f32_32x32x16_bf16 v[128:143], v[184:187], v[172:175], v[128:143]
    v_exp_f32 v29, v29
    v_exp_f32 v30, v30
    s_waitcnt vmcnt(6)
    ds_read_b64_tr_b16 v[176:177], v8 offset:0
    ds_read_b64_tr_b16 v[178:179], v8 offset:1024
    ds_read_b64_tr_b16 v[180:181], v9 offset:0
    ds_read_b64_tr_b16 v[182:183], v9 offset:1024
    v_cvt_pk_bf16_f32 v70, v28, v29
    v_exp_f32 v31, v31
    v_exp_f32 v32, v32
    v_cvt_pk_bf16_f32 v71, v30, v31
    v_exp_f32 v33, v33
    v_exp_f32 v34, v34
    v_mfma_f32_32x32x16_bf16 v[112:127], a[36:39], v[68:71], v[112:127]
    v_cvt_pk_bf16_f32 v64, v32, v33
    s_add_u32 m0, s66, 6144
    s_nop 0
    buffer_load_dwordx4 v7, s[12:15], s73 offen lds
    s_add_u32 s73, s73, 16384
    v_exp_f32 v35, v35
    v_exp_f32 v36, v36
    v_cvt_pk_bf16_f32 v65, v34, v35
    v_mfma_f32_32x32x16_bf16 v[16:31], v[104:107], v[76:79], v[48:63]
    v_exp_f32 v37, v37
    s_add_u32 m0, s66, 7168
    s_nop 0
    buffer_load_dwordx4 v7, s[12:15], s74 offen lds
    s_add_u32 s74, s74, 16384
    v_exp_f32 v38, v38
    v_cvt_pk_bf16_f32 v66, v36, v37
    v_mfma_f32_32x32x16_bf16 v[144:159], v[188:191], v[172:175], v[144:159]
    v_exp_f32 v39, v39
    v_exp_f32 v40, v40
    v_cvt_pk_bf16_f32 v67, v38, v39
    v_exp_f32 v41, v41
    v_exp_f32 v42, v42
    v_mfma_f32_32x32x16_bf16 v[112:127], a[40:43], v[64:67], v[112:127]
    v_cvt_pk_bf16_f32 v68, v40, v41
    buffer_load_dwordx4 v[172:175], v2, s[8:11], s72 offen sc1
    s_add_u32 s72, s72, 1024
    v_exp_f32 v43, v43
    v_exp_f32 v44, v44
    v_cvt_pk_bf16_f32 v69, v42, v43
    s_waitcnt lgkmcnt(0)
    v_mfma_f32_32x32x16_bf16 v[128:143], v[176:179], v[160:163], v[128:143]
    v_exp_f32 v45, v45
    v_exp_f32 v46, v46
    v_cvt_pk_bf16_f32 v70, v44, v45
    v_exp_f32 v47, v47
    v_exp_f32 v16, v16
    v_cvt_pk_bf16_f32 v71, v46, v47
    v_exp_f32 v17, v17
    v_exp_f32 v18, v18
    v_mfma_f32_32x32x16_bf16 v[112:127], a[44:47], v[68:71], v[112:127]
    v_cvt_pk_bf16_f32 v64, v16, v17
    v_exp_f32 v19, v19
    v_exp_f32 v20, v20
    v_cvt_pk_bf16_f32 v65, v18, v19
    v_mfma_f32_32x32x16_bf16 v[32:47], v[108:111], v[76:79], v[48:63]
    v_exp_f32 v21, v21
    v_exp_f32 v22, v22
    v_cvt_pk_bf16_f32 v66, v20, v21
    v_exp_f32 v23, v23
    v_exp_f32 v24, v24
    v_cvt_pk_bf16_f32 v67, v22, v23
    v_exp_f32 v25, v25
    v_exp_f32 v26, v26
    v_mfma_f32_32x32x16_bf16 v[112:127], a[48:51], v[64:67], v[112:127]
    v_cvt_pk_bf16_f32 v68, v24, v25
    v_exp_f32 v27, v27
    v_exp_f32 v28, v28
    v_cvt_pk_bf16_f32 v69, v26, v27
    v_mfma_f32_32x32x16_bf16 v[144:159], v[180:183], v[160:163], v[144:159]
    v_exp_f32 v29, v29
    v_exp_f32 v30, v30
    s_waitcnt vmcnt(6)
    ds_read_b64_tr_b16 v[184:185], v8 offset:2048
    ds_read_b64_tr_b16 v[186:187], v8 offset:3072
    ds_read_b64_tr_b16 v[188:189], v9 offset:2048
    ds_read_b64_tr_b16 v[190:191], v9 offset:3072
    v_cvt_pk_bf16_f32 v70, v28, v29
    v_exp_f32 v31, v31
    s_cmp_eq_u32 s60, 0
    s_cbranch_scc1 SLOWC_I5
    ds_read_b32 v16, v13 offset:256
    ds_read_b32 v17, v13 offset:1280
    ds_read_b32 v18, v13 offset:2304
    ds_read_b32 v19, v13 offset:3328
    s_waitcnt lgkmcnt(0)
    v_max_f32 v16, v16, v17
    v_max_f32 v16, v16, v18
    v_max_f32 v16, v16, v19
    v_sub_f32 v16, 0, v16
    s_nop 7
    v_mov_b32 v48, v16
    v_mov_b32 v49, v16
    v_mov_b32 v50, v16
    v_mov_b32 v51, v16
    v_mov_b32 v52, v16
    v_mov_b32 v53, v16
    v_mov_b32 v54, v16
    v_mov_b32 v55, v16
    v_mov_b32 v56, v16
    v_mov_b32 v57, v16
    v_mov_b32 v58, v16
    v_mov_b32 v59, v16
    v_mov_b32 v60, v16
    v_mov_b32 v61, v16
    v_mov_b32 v62, v16
    v_mov_b32 v63, v16
    s_nop 1
SLOWC_I5:
    v_exp_f32 v32, v32
    s_waitcnt vmcnt(12)
    v_cvt_pk_bf16_f32 v71, v30, v31
    v_exp_f32 v33, v33
    v_exp_f32 v34, v34
    v_mfma_f32_32x32x16_bf16 v[112:127], a[52:55], v[68:71], v[112:127]
    v_cvt_pk_bf16_f32 v64, v32, v33
    buffer_load_dword v10, v11, s[20:23], s75 offen sc1
    s_add_u32 m0, s66, 0
    s_nop 0
    buffer_load_dwordx4 v7, s[12:15], s73 offen lds
    s_add_u32 s73, s73, 16384
    v_exp_f32 v35, v35
    v_exp_f32 v36, v36
    v_cvt_pk_bf16_f32 v65, v34, v35
    v_mfma_f32_32x32x16_bf16 v[16:31], v[80:83], v[72:75], v[48:63]
    v_exp_f32 v37, v37
    s_add_u32 m0, s66, 1024
    s_nop 0
    buffer_load_dwordx4 v7, s[12:15], s74 offen lds
    s_add_u32 s74, s74, 16384
    v_exp_f32 v38, v38
    v_cvt_pk_bf16_f32 v66, v36, v37
    v_exp_f32 v39, v39
    v_exp_f32 v40, v40
    v_cvt_pk_bf16_f32 v67, v38, v39
    v_exp_f32 v41, v41
    v_exp_f32 v42, v42
    v_mfma_f32_32x32x16_bf16 v[112:127], a[56:59], v[64:67], v[112:127]
    v_cvt_pk_bf16_f32 v68, v40, v41
    buffer_load_dwordx4 v[160:163], v2, s[8:11], s72 offen sc1
    s_add_u32 s72, s72, 1024
    v_exp_f32 v43, v43
    v_exp_f32 v44, v44
    v_cvt_pk_bf16_f32 v69, v42, v43
    s_waitcnt lgkmcnt(0)
    v_mfma_f32_32x32x16_bf16 v[128:143], v[184:187], v[164:167], v[128:143]
    v_exp_f32 v45, v45
    v_exp_f32 v46, v46
    v_cvt_pk_bf16_f32 v70, v44, v45
    v_exp_f32 v47, v47
    v_exp_f32 v16, v16
    v_cvt_pk_bf16_f32 v71, v46, v47
    s_add_u32 s48, s59, 3072
    buffer_load_dwordx4 v[76:79], v2, s[20:23], s48 offen sc1
    v_exp_f32 v17, v17
    v_exp_f32 v18, v18
    v_mfma_f32_32x32x16_bf16 v[112:127], a[60:63], v[68:71], v[112:127]
    v_cvt_pk_bf16_f32 v64, v16, v17
    v_exp_f32 v19, v19
    v_exp_f32 v20, v20
    v_cvt_pk_bf16_f32 v65, v18, v19
    v_mfma_f32_32x32x16_bf16 v[32:47], v[84:87], v[72:75], v[48:63]
    v_exp_f32 v21, v21
    v_exp_f32 v22, v22
    v_cvt_pk_bf16_f32 v66, v20, v21
    v_exp_f32 v23, v23
    v_exp_f32 v24, v24
    v_cvt_pk_bf16_f32 v67, v22, v23
    v_exp_f32 v25, v25
    ds_write_b128 v6, v[112:115] offset:2304
    ds_write_b128 v6, v[116:119] offset:3328
    ds_write_b32 v0, v120 offset:4352
    ds_read_b128 v[112:115], v6 offset:4608
    ds_read_b128 v[116:119], v6 offset:5632
    ds_read_b32 v120, v0 offset:6656
    v_exp_f32 v26, v26
    v_cvt_pk_bf16_f32 v68, v24, v25
    v_exp_f32 v27, v27
    v_exp_f32 v28, v28
    v_cvt_pk_bf16_f32 v69, v26, v27
    v_mfma_f32_32x32x16_bf16 v[144:159], v[188:191], v[164:167], v[144:159]
    v_exp_f32 v29, v29
    v_exp_f32 v30, v30
    s_waitcnt vmcnt(8)
    ds_read_b64_tr_b16 v[176:177], v8 offset:4096
    ds_read_b64_tr_b16 v[178:179], v8 offset:5120
    ds_read_b64_tr_b16 v[180:181], v9 offset:4096
    ds_read_b64_tr_b16 v[182:183], v9 offset:5120
    v_cvt_pk_bf16_f32 v70, v28, v29
    v_exp_f32 v31, v31
    s_waitcnt lgkmcnt(4)
    v_mfma_f32_32x32x16_bf16 v[112:127], a[0:3], v[64:67], v[112:127]
    v_exp_f32 v32, v32
    v_cvt_pk_bf16_f32 v71, v30, v31
    v_exp_f32 v33, v33
    v_exp_f32 v34, v34
    v_mfma_f32_32x32x16_bf16 v[112:127], a[4:7], v[68:71], v[112:127]
    v_cvt_pk_bf16_f32 v64, v32, v33
    s_add_u32 m0, s66, 2048
    s_nop 0
    buffer_load_dwordx4 v7, s[12:15], s73 offen lds
    s_add_u32 s73, s73, 16384
    v_exp_f32 v35, v35
    v_exp_f32 v36, v36
    v_cvt_pk_bf16_f32 v65, v34, v35
    v_mfma_f32_32x32x16_bf16 v[16:31], v[88:91], v[72:75], v[48:63]
    v_exp_f32 v37, v37
    s_add_u32 m0, s66, 3072
    s_nop 0
    buffer_load_dwordx4 v7, s[12:15], s74 offen lds
    s_add_u32 s74, s74, 16384
    v_exp_f32 v38, v38
    v_cvt_pk_bf16_f32 v66, v36, v37
    v_exp_f32 v39, v39
    v_exp_f32 v40, v40
    v_cvt_pk_bf16_f32 v67, v38, v39
    v_exp_f32 v41, v41
    v_exp_f32 v42, v42
    v_mfma_f32_32x32x16_bf16 v[112:127], a[8:11], v[64:67], v[112:127]
    v_cvt_pk_bf16_f32 v68, v40, v41
    buffer_load_dwordx4 v[164:167], v2, s[8:11], s72 offen sc1
    s_add_u32 s72, s72, 1024
    v_exp_f32 v43, v43
    v_exp_f32 v44, v44
    v_cvt_pk_bf16_f32 v69, v42, v43
    s_waitcnt lgkmcnt(0)
    v_mfma_f32_32x32x16_bf16 v[128:143], v[176:179], v[168:171], v[128:143]
    v_exp_f32 v45, v45
    v_exp_f32 v46, v46
    v_cvt_pk_bf16_f32 v70, v44, v45
    v_exp_f32 v47, v47
    v_exp_f32 v16, v16
    v_cvt_pk_bf16_f32 v71, v46, v47
    v_exp_f32 v17, v17
    v_exp_f32 v18, v18
    v_mfma_f32_32x32x16_bf16 v[112:127], a[12:15], v[68:71], v[112:127]
    v_cvt_pk_bf16_f32 v64, v16, v17
    v_exp_f32 v19, v19
    v_exp_f32 v20, v20
    v_cvt_pk_bf16_f32 v65, v18, v19
    v_mfma_f32_32x32x16_bf16 v[32:47], v[92:95], v[72:75], v[48:63]
    v_exp_f32 v21, v21
    v_exp_f32 v22, v22
    v_cvt_pk_bf16_f32 v66, v20, v21
    v_exp_f32 v23, v23
    v_exp_f32 v24, v24
    v_cvt_pk_bf16_f32 v67, v22, v23
    v_exp_f32 v25, v25
    v_exp_f32 v26, v26
    v_mfma_f32_32x32x16_bf16 v[112:127], a[16:19], v[64:67], v[112:127]
    v_cvt_pk_bf16_f32 v68, v24, v25
    v_exp_f32 v27, v27
    v_exp_f32 v28, v28
    v_cvt_pk_bf16_f32 v69, v26, v27
    v_mfma_f32_32x32x16_bf16 v[144:159], v[180:183], v[168:171], v[144:159]
    v_exp_f32 v29, v29
    v_exp_f32 v30, v30
    s_waitcnt vmcnt(8)
    ds_read_b64_tr_b16 v[184:185], v8 offset:6144
    ds_read_b64_tr_b16 v[186:187], v8 offset:7168
    ds_read_b64_tr_b16 v[188:189], v9 offset:6144
    ds_read_b64_tr_b16 v[190:191], v9 offset:7168
    v_cvt_pk_bf16_f32 v70, v28, v29
    v_exp_f32 v31, v31
    v_exp_f32 v32, v32
    v_cvt_pk_bf16_f32 v71, v30, v31
    v_exp_f32 v33, v33
    v_exp_f32 v34, v34
    v_mfma_f32_32x32x16_bf16 v[112:127], a[20:23], v[68:71], v[112:127]
    v_cvt_pk_bf16_f32 v64, v32, v33
    s_add_u32 m0, s66, 4096
    s_nop 0
    buffer_load_dwordx4 v7, s[12:15], s73 offen lds
    s_add_u32 s73, s73, 16384
    v_exp_f32 v35, v35
    v_exp_f32 v36, v36
    v_cvt_pk_bf16_f32 v65, v34, v35
    v_mfma_f32_32x32x16_bf16 v[16:31], v[96:99], v[72:75], v[48:63]
    v_exp_f32 v37, v37
    s_add_u32 m0, s66, 5120
    s_nop 0
    buffer_load_dwordx4 v7, s[12:15], s74 offen lds
    s_add_u32 s74, s74, 16384
    v_exp_f32 v38, v38
    v_cvt_pk_bf16_f32 v66, v36, v37
    v_exp_f32 v39, v39
    v_exp_f32 v40, v40
    v_cvt_pk_bf16_f32 v67, v38, v39
    v_exp_f32 v41, v41
    v_exp_f32 v42, v42
    v_mfma_f32_32x32x16_bf16 v[112:127], a[24:27], v[64:67], v[112:127]
    v_cvt_pk_bf16_f32 v68, v40, v41
    buffer_load_dwordx4 v[168:171], v2, s[8:11], s72 offen sc1
    s_add_u32 s72, s72, 1024
    v_exp_f32 v43, v43
    v_exp_f32 v44, v44
    v_cvt_pk_bf16_f32 v69, v42, v43
    s_waitcnt lgkmcnt(0)
    v_mfma_f32_32x32x16_bf16 v[128:143], v[184:187], v[172:175], v[128:143]
    v_exp_f32 v45, v45
    v_exp_f32 v46, v46
    v_cvt_pk_bf16_f32 v70, v44, v45
    v_exp_f32 v47, v47
    v_exp_f32 v16, v16
    v_cvt_pk_bf16_f32 v71, v46, v47
    v_exp_f32 v17, v17
    v_exp_f32 v18, v18
    v_mfma_f32_32x32x16_bf16 v[112:127], a[28:31], v[68:71], v[112:127]
    v_cvt_pk_bf16_f32 v64, v16, v17
    v_exp_f32 v19, v19
    v_exp_f32 v20, v20
    v_cvt_pk_bf16_f32 v65, v18, v19
    v_mfma_f32_32x32x16_bf16 v[32:47], v[100:103], v[72:75], v[48:63]
    v_exp_f32 v21, v21
    v_exp_f32 v22, v22
    v_cvt_pk_bf16_f32 v66, v20, v21
    v_exp_f32 v23, v23
    v_exp_f32 v24, v24
    v_cvt_pk_bf16_f32 v67, v22, v23
    v_exp_f32 v25, v25
    v_exp_f32 v26, v26
    v_mfma_f32_32x32x16_bf16 v[112:127], a[32:35], v[64:67], v[112:127]
    v_cvt_pk_bf16_f32 v68, v24, v25
    v_exp_f32 v27, v27
    v_exp_f32 v28, v28
    v_cvt_pk_bf16_f32 v69, v26, v27
    v_mfma_f32_32x32x16_bf16 v[144:159], v[188:191], v[172:175], v[144:159]
    v_exp_f32 v29, v29
    v_exp_f32 v30, v30
    s_waitcnt vmcnt(7)
    ds_read_b64_tr_b16 v[176:177], v8 offset:0
    ds_read_b64_tr_b16 v[178:179], v8 offset:1024
    ds_read_b64_tr_b16 v[180:181], v9 offset:0
    ds_read_b64_tr_b16 v[182:183], v9 offset:1024
    v_cvt_pk_bf16_f32 v70, v28, v29
    v_exp_f32 v31, v31
    v_exp_f32 v32, v32
    v_cvt_pk_bf16_f32 v71, v30, v31
    s_waitcnt vmcnt(10)
    v_cmp_ne_u32 vcc, s56, v10
    s_nop 3
    s_cmp_eq_u64 vcc, 0
    s_cbranch_scc1 FG_OK
    s_call_b64 s[0:1], FG_SPIN
FG_OK:
    v_and_b32 v3, 31, v1
    v_lshlrev_b32 v3, 2, v3
    s_lshl_b32 s48, s70, 1
    s_and_b32 s49, s24, 1
    s_add_u32 s48, s48, s49
    s_lshl_b32 s48, s48, 7
    s_add_u32 s48, s48, 0xe04000
    buffer_load_dword v14, v3, s[20:23], s48 offen sc1
    v_exp_f32 v33, v33
    v_exp_f32 v34, v34
    v_mfma_f32_32x32x16_bf16 v[112:127], a[36:39], v[68:71], v[112:127]
    v_cvt_pk_bf16_f32 v64, v32, v33
    s_add_u32 m0, s66, 6144
    s_nop 0
    buffer_load_dwordx4 v7, s[12:15], s73 offen lds
    s_add_u32 s73, s73, 16384
    v_exp_f32 v35, v35
    v_exp_f32 v36, v36
    v_cvt_pk_bf16_f32 v65, v34, v35
    v_mfma_f32_32x32x16_bf16 v[16:31], v[104:107], v[72:75], v[48:63]
    v_exp_f32 v37, v37
    s_add_u32 m0, s66, 7168
    s_nop 0
    buffer_load_dwordx4 v7, s[12:15], s74 offen lds
    s_add_u32 s74, s74, 16384
    v_exp_f32 v38, v38
    v_cvt_pk_bf16_f32 v66, v36, v37
    v_exp_f32 v39, v39
    v_exp_f32 v40, v40
    v_cvt_pk_bf16_f32 v67, v38, v39
    v_exp_f32 v41, v41
    v_exp_f32 v42, v42
    v_mfma_f32_32x32x16_bf16 v[112:127], a[40:43], v[64:67], v[112:127]
    v_cvt_pk_bf16_f32 v68, v40, v41
    buffer_load_dwordx4 v[172:175], v2, s[8:11], s72 offen sc1
    s_add_u32 s72, s72, 1024
    v_exp_f32 v43, v43
    v_exp_f32 v44, v44
    v_cvt_pk_bf16_f32 v69, v42, v43
    s_waitcnt lgkmcnt(0)
    v_mfma_f32_32x32x16_bf16 v[128:143], v[176:179], v[160:163], v[128:143]
    v_exp_f32 v45, v45
    v_exp_f32 v46, v46
    s_waitcnt vmcnt(7)
    ds_read_b64_tr_b16 v[184:185], v8 offset:2048
    ds_read_b64_tr_b16 v[186:187], v8 offset:3072
    ds_read_b64_tr_b16 v[188:189], v9 offset:2048
    ds_read_b64_tr_b16 v[190:191], v9 offset:3072
    v_cvt_pk_bf16_f32 v70, v44, v45
    v_exp_f32 v47, v47
    v_exp_f32 v16, v16
    v_cvt_pk_bf16_f32 v71, v46, v47
    v_exp_f32 v17, v17
    v_exp_f32 v18, v18
    v_mfma_f32_32x32x16_bf16 v[112:127], a[44:47], v[68:71], v[112:127]
    v_cvt_pk_bf16_f32 v64, v16, v17
    s_add_u32 m0, s66, 0
    s_nop 0
    buffer_load_dwordx4 v7, s[12:15], s73 offen lds
    s_add_u32 s73, s73, 16384
    v_exp_f32 v19, v19
    v_exp_f32 v20, v20
    v_cvt_pk_bf16_f32 v65, v18, v19
    v_mfma_f32_32x32x16_bf16 v[32:47], v[108:111], v[72:75], v[48:63]
    v_exp_f32 v21, v21
    s_add_u32 m0, s66, 1024
    s_nop 0
    buffer_load_dwordx4 v7, s[12:15], s74 offen lds
    s_add_u32 s74, s74, 16384
    v_exp_f32 v22, v22
    v_cvt_pk_bf16_f32 v66, v20, v21
    v_mfma_f32_32x32x16_bf16 v[144:159], v[180:183], v[160:163], v[144:159]
    v_exp_f32 v23, v23
    v_exp_f32 v24, v24
    v_cvt_pk_bf16_f32 v67, v22, v23
    v_exp_f32 v25, v25
    v_exp_f32 v26, v26
    v_mfma_f32_32x32x16_bf16 v[112:127], a[48:51], v[64:67], v[112:127]
    v_cvt_pk_bf16_f32 v68, v24, v25
    s_cmp_ge_u32 s24, 6
    s_cselect_b32 s48, 0x40000000, s72
    buffer_load_dwordx4 v[160:163], v2, s[8:11], s48 offen sc1
    s_add_u32 s72, s72, 1024
    v_exp_f32 v27, v27
    v_exp_f32 v28, v28
    v_cvt_pk_bf16_f32 v69, v26, v27
    s_waitcnt lgkmcnt(0)
    v_mfma_f32_32x32x16_bf16 v[128:143], v[184:187], v[164:167], v[128:143]
    v_exp_f32 v29, v29
    v_exp_f32 v30, v30
    v_cvt_pk_bf16_f32 v70, v28, v29
    v_exp_f32 v31, v31
    s_cmp_eq_u32 s60, 0
    s_cbranch_scc1 SLOWC_I6
    ds_read_b32 v16, v13 offset:384
    ds_read_b32 v17, v13 offset:1408
    ds_read_b32 v18, v13 offset:2432
    ds_read_b32 v19, v13 offset:3456
    s_waitcnt lgkmcnt(0)
    v_max_f32 v16, v16, v17
    v_max_f32 v16, v16, v18
    v_max_f32 v16, v16, v19
    v_sub_f32 v16, 0, v16
    s_nop 7
    v_mov_b32 v48, v16
    v_mov_b32 v49, v16
    v_mov_b32 v50, v16
    v_mov_b32 v51, v16
    v_mov_b32 v52, v16
    v_mov_b32 v53, v16
    v_mov_b32 v54, v16
    v_mov_b32 v55, v16
    v_mov_b32 v56, v16
    v_mov_b32 v57, v16
    v_mov_b32 v58, v16
    v_mov_b32 v59, v16
    v_mov_b32 v60, v16
    v_mov_b32 v61, v16
    v_mov_b32 v62, v16
    v_mov_b32 v63, v16
    s_nop 1
SLOWC_I6:
    v_exp_f32 v32, v32
    s_waitcnt vmcnt(13)
    v_cvt_pk_bf16_f32 v71, v30, v31
    v_exp_f32 v33, v33
    v_exp_f32 v34, v34
    v_mfma_f32_32x32x16_bf16 v[112:127], a[52:55], v[68:71], v[112:127]
    v_cvt_pk_bf16_f32 v64, v32, v33
    v_exp_f32 v35, v35
    v_exp_f32 v36, v36
    v_cvt_pk_bf16_f32 v65, v34, v35
    v_mfma_f32_32x32x16_bf16 v[16:31], v[80:83], v[76:79], v[48:63]
    v_exp_f32 v37, v37
    v_exp_f32 v38, v38
    v_cvt_pk_bf16_f32 v66, v36, v37
    v_exp_f32 v39, v39
    v_exp_f32 v40, v40
    v_cvt_pk_bf16_f32 v67, v38, v39
    v_exp_f32 v41, v41
    v_exp_f32 v42, v42
    v_mfma_f32_32x32x16_bf16 v[112:127], a[56:59], v[64:67], v[112:127]
    v_cvt_pk_bf16_f32 v68, v40, v41
    v_exp_f32 v43, v43
    v_exp_f32 v44, v44
    v_cvt_pk_bf16_f32 v69, v42, v43
    v_mfma_f32_32x32x16_bf16 v[144:159], v[188:191], v[164:167], v[144:159]
    v_exp_f32 v45, v45
    v_exp_f32 v46, v46
    s_waitcnt vmcnt(7)
    ds_read_b64_tr_b16 v[176:177], v8 offset:4096
    ds_read_b64_tr_b16 v[178:179], v8 offset:5120
    ds_read_b64_tr_b16 v[180:181], v9 offset:4096
    ds_read_b64_tr_b16 v[182:183], v9 offset:5120
    v_cvt_pk_bf16_f32 v70, v44, v45
    v_exp_f32 v47, v47
    v_exp_f32 v16, v16
    v_cvt_pk_bf16_f32 v71, v46, v47
    s_add_u32 s48, s59, 0
    buffer_load_dwordx4 v[72:75], v2, s[20:23], s48 offen sc1
    v_exp_f32 v17, v17
    v_exp_f32 v18, v18
    v_mfma_f32_32x32x16_bf16 v[112:127], a[60:63], v[68:71], v[112:127]
    v_cvt_pk_bf16_f32 v64, v16, v17
    s_add_u32 m0, s66, 2048
    s_nop 0
    buffer_load_dwordx4 v7, s[12:15], s73 offen lds
    s_add_u32 s73, s73, 16384
    v_exp_f32 v19, v19
    v_exp_f32 v20, v20
    v_cvt_pk_bf16_f32 v65, v18, v19
    v_mfma_f32_32x32x16_bf16 v[32:47], v[84:87], v[76:79], v[48:63]
    v_exp_f32 v21, v21
    s_add_u32 m0, s66, 3072
    s_nop 0
    buffer_load_dwordx4 v7, s[12:15], s74 offen lds
    s_add_u32 s74, s74, 16384
    v_exp_f32 v22, v22
    v_cvt_pk_bf16_f32 v66, v20, v21
    v_exp_f32 v23, v23
    v_exp_f32 v24, v24
    v_cvt_pk_bf16_f32 v67, v22, v23
    v_exp_f32 v25, v25
    ds_write_b128 v6, v[112:115] offset:4608
    ds_write_b128 v6, v[116:119] offset:5632
    ds_write_b32 v0, v120 offset:6656
    ds_read_b128 v[112:115], v6 offset:6912
    ds_read_b128 v[116:119], v6 offset:7936
    ds_read_b32 v120, v0 offset:8960
    v_exp_f32 v26, v26
    v_cvt_pk_bf16_f32 v68, v24, v25
    s_cmp_ge_u32 s24, 6
    s_cselect_b32 s48, 0x40000000, s72
    buffer_load_dwordx4 v[164:167], v2, s[8:11], s48 offen sc1
    s_add_u32 s72, s72, 1024
    v_exp_f32 v27, v27
    v_exp_f32 v28, v28
    v_cvt_pk_bf16_f32 v69, v26, v27
    s_waitcnt lgkmcnt(6)
    v_mfma_f32_32x32x16_bf16 v[128:143], v[176:179], v[168:171], v[128:143]
    v_exp_f32 v29, v29
    v_exp_f32 v30, v30
    v_cvt_pk_bf16_f32 v70, v28, v29
    v_exp_f32 v31, v31
    s_waitcnt lgkmcnt(0)
    v_mfma_f32_32x32x16_bf16 v[112:127], a[0:3], v[64:67], v[112:127]
    v_exp_f32 v32, v32
    v_cvt_pk_bf16_f32 v71, v30, v31
    s_lshl_b32 s73, s24, 16
    s_lshl_b32 s49, s71, 7
    s_add_u32 s73, s73, s49
    s_add_u32 s74, s73, 8192
    v_exp_f32 v33, v33
    v_exp_f32 v34, v34
    v_mfma_f32_32x32x16_bf16 v[112:127], a[4:7], v[68:71], v[112:127]
    v_cvt_pk_bf16_f32 v64, v32, v33
    v_exp_f32 v35, v35
    s_add_u32 m0, s66, 4096
    s_add_u32 s50, s73, 32768
    buffer_load_dwordx4 v7, s[44:47], s50 offen lds
    v_exp_f32 v36, v36
    v_cvt_pk_bf16_f32 v65, v34, v35
    v_mfma_f32_32x32x16_bf16 v[16:31], v[88:91], v[76:79], v[48:63]
    v_exp_f32 v37, v37
    v_exp_f32 v38, v38
    s_add_u32 m0, s66, 5120
    s_add_u32 s50, s74, 32768
    buffer_load_dwordx4 v7, s[44:47], s50 offen lds
    v_cvt_pk_bf16_f32 v66, v36, v37
    v_exp_f32 v39, v39
    v_exp_f32 v40, v40
    v_cvt_pk_bf16_f32 v67, v38, v39
    v_exp_f32 v41, v41
    v_exp_f32 v42, v42
    v_mfma_f32_32x32x16_bf16 v[112:127], a[8:11], v[64:67], v[112:127]
    v_cvt_pk_bf16_f32 v68, v40, v41
    v_exp_f32 v43, v43
    v_exp_f32 v44, v44
    v_cvt_pk_bf16_f32 v69, v42, v43
    v_mfma_f32_32x32x16_bf16 v[144:159], v[180:183], v[168:171], v[144:159]
    v_exp_f32 v45, v45
    v_exp_f32 v46, v46
    s_waitcnt vmcnt(9)
    ds_read_b64_tr_b16 v[184:185], v8 offset:6144
    ds_read_b64_tr_b16 v[186:187], v8 offset:7168
    ds_read_b64_tr_b16 v[188:189], v9 offset:6144
    ds_read_b64_tr_b16 v[190:191], v9 offset:7168
    v_cvt_pk_bf16_f32 v70, v44, v45
    v_exp_f32 v47, v47
    v_exp_f32 v16, v16
    v_cvt_pk_bf16_f32 v71, v46, v47
    v_exp_f32 v17, v17
    v_exp_f32 v18, v18
    v_mfma_f32_32x32x16_bf16 v[112:127], a[12:15], v[68:71], v[112:127]
    v_cvt_pk_bf16_f32 v64, v16, v17
    v_exp_f32 v19, v19
    v_exp_f32 v20, v20
    v_cvt_pk_bf16_f32 v65, v18, v19
    v_mfma_f32_32x32x16_bf16 v[32:47], v[92:95], v[76:79], v[48:63]
    v_exp_f32 v21, v21
    v_exp_f32 v22, v22
    v_cvt_pk_bf16_f32 v66, v20, v21
    v_exp_f32 v23, v23
    v_exp_f32 v24, v24
    v_cvt_pk_bf16_f32 v67, v22, v23
    v_exp_f32 v25, v25
    v_exp_f32 v26, v26
    v_mfma_f32_32x32x16_bf16 v[112:127], a[16:19], v[64:67], v[112:127]
    v_cvt_pk_bf16_f32 v68, v24, v25
    v_exp_f32 v27, v27
    v_exp_f32 v28, v28
    v_cvt_pk_bf16_f32 v69, v26, v27
    s_waitcnt lgkmcnt(0)
    v_mfma_f32_32x32x16_bf16 v[128:143], v[184:187], v[172:175], v[128:143]
    v_exp_f32 v29, v29
    v_exp_f32 v30, v30
    v_cvt_pk_bf16_f32 v70, v28, v29
    v_exp_f32 v31, v31
    v_exp_f32 v32, v32
    v_cvt_pk_bf16_f32 v71, v30, v31
    v_exp_f32 v33, v33
    v_exp_f32 v34, v34
    v_mfma_f32_32x32x16_bf16 v[112:127], a[20:23], v[68:71], v[112:127]
    v_cvt_pk_bf16_f32 v64, v32, v33
    v_exp_f32 v35, v35
    s_add_u32 m0, s66, 6144
    s_add_u32 s50, s73, 49152
    buffer_load_dwordx4 v7, s[44:47], s50 offen lds
    v_exp_f32 v36, v36
    v_cvt_pk_bf16_f32 v65, v34, v35
    v_mfma_f32_32x32x16_bf16 v[16:31], v[96:99], v[76:79], v[48:63]
    v_exp_f32 v37, v37
    v_exp_f32 v38, v38
    s_add_u32 m0, s66, 7168
    s_add_u32 s50, s74, 49152
    buffer_load_dwordx4 v7, s[44:47], s50 offen lds
    v_cvt_pk_bf16_f32 v66, v36, v37
    v_exp_f32 v39, v39
    v_exp_f32 v40, v40
    v_cvt_pk_bf16_f32 v67, v38, v39
    v_exp_f32 v41, v41
    v_exp_f32 v42, v42
    v_mfma_f32_32x32x16_bf16 v[112:127], a[24:27], v[64:67], v[112:127]
    v_cvt_pk_bf16_f32 v68, v40, v41
    v_exp_f32 v43, v43
    v_exp_f32 v44, v44
    v_cvt_pk_bf16_f32 v69, v42, v43
    v_mfma_f32_32x32x16_bf16 v[144:159], v[188:191], v[172:175], v[144:159]
    v_exp_f32 v45, v45
    v_exp_f32 v46, v46
    s_waitcnt vmcnt(8)
    ds_read_b64_tr_b16 v[176:177], v8 offset:0
    ds_read_b64_tr_b16 v[178:179], v8 offset:1024
    ds_read_b64_tr_b16 v[180:181], v9 offset:0
    ds_read_b64_tr_b16 v[182:183], v9 offset:1024
    v_cvt_pk_bf16_f32 v70, v44, v45
    v_exp_f32 v47, v47
    v_exp_f32 v16, v16
    v_cvt_pk_bf16_f32 v71, v46, v47
    v_exp_f32 v17, v17
    v_exp_f32 v18, v18
    v_mfma_f32_32x32x16_bf16 v[112:127], a[28:31], v[68:71], v[112:127]
    v_cvt_pk_bf16_f32 v64, v16, v17
    v_exp_f32 v19, v19
    v_exp_f32 v20, v20
    v_cvt_pk_bf16_f32 v65, v18, v19
    v_mfma_f32_32x32x16_bf16 v[32:47], v[100:103], v[76:79], v[48:63]
    v_exp_f32 v21, v21
    v_exp_f32 v22, v22
    v_cvt_pk_bf16_f32 v66, v20, v21
    v_exp_f32 v23, v23
    v_exp_f32 v24, v24
    v_cvt_pk_bf16_f32 v67, v22, v23
    v_exp_f32 v25, v25
    v_exp_f32 v26, v26
    v_mfma_f32_32x32x16_bf16 v[112:127], a[32:35], v[64:67], v[112:127]
    v_cvt_pk_bf16_f32 v68, v24, v25
    v_exp_f32 v27, v27
    v_exp_f32 v28, v28
    v_cvt_pk_bf16_f32 v69, v26, v27
    s_waitcnt lgkmcnt(0)
    v_mfma_f32_32x32x16_bf16 v[128:143], v[176:179], v[160:163], v[128:143]
    v_exp_f32 v29, v29
    v_exp_f32 v30, v30
    v_cvt_pk_bf16_f32 v70, v28, v29
    v_exp_f32 v31, v31
    v_exp_f32 v32, v32
    v_cvt_pk_bf16_f32 v71, v30, v31
    v_exp_f32 v33, v33
    v_exp_f32 v34, v34
    v_mfma_f32_32x32x16_bf16 v[112:127], a[36:39], v[68:71], v[112:127]
    v_cvt_pk_bf16_f32 v64, v32, v33
    v_exp_f32 v35, v35
    s_add_u32 m0, s66, 0
    s_add_u32 s50, s73, 0
    buffer_load_dwordx4 v7, s[44:47], s50 offen lds
    v_exp_f32 v36, v36
    v_cvt_pk_bf16_f32 v65, v34, v35
    v_mfma_f32_32x32x16_bf16 v[16:31], v[104:107], v[76:79], v[48:63]
    v_exp_f32 v37, v37
    v_exp_f32 v38, v38
    s_add_u32 m0, s66, 1024
    s_add_u32 s50, s74, 0
    buffer_load_dwordx4 v7, s[44:47], s50 offen lds
    v_cvt_pk_bf16_f32 v66, v36, v37
    v_exp_f32 v39, v39
    v_exp_f32 v40, v40
    v_cvt_pk_bf16_f32 v67, v38, v39
    v_exp_f32 v41, v41
    v_exp_f32 v42, v42
    v_mfma_f32_32x32x16_bf16 v[112:127], a[40:43], v[64:67], v[112:127]
    v_cvt_pk_bf16_f32 v68, v40, v41
    v_exp_f32 v43, v43
    v_exp_f32 v44, v44
    v_cvt_pk_bf16_f32 v69, v42, v43
    v_mfma_f32_32x32x16_bf16 v[144:159], v[180:183], v[160:163], v[144:159]
    v_exp_f32 v45, v45
    v_exp_f32 v46, v46
    s_waitcnt vmcnt(6)
    ds_read_b64_tr_b16 v[184:185], v8 offset:2048
    ds_read_b64_tr_b16 v[186:187], v8 offset:3072
    ds_read_b64_tr_b16 v[188:189], v9 offset:2048
    ds_read_b64_tr_b16 v[190:191], v9 offset:3072
    v_cvt_pk_bf16_f32 v70, v44, v45
    v_exp_f32 v47, v47
    v_exp_f32 v16, v16
    v_cvt_pk_bf16_f32 v71, v46, v47
    v_exp_f32 v17, v17
    v_exp_f32 v18, v18
    v_mfma_f32_32x32x16_bf16 v[112:127], a[44:47], v[68:71], v[112:127]
    v_cvt_pk_bf16_f32 v64, v16, v17
    v_exp_f32 v19, v19
    v_exp_f32 v20, v20
    v_cvt_pk_bf16_f32 v65, v18, v19
    v_mfma_f32_32x32x16_bf16 v[32:47], v[108:111], v[76:79], v[48:63]
    v_exp_f32 v21, v21
    v_exp_f32 v22, v22
    v_cvt_pk_bf16_f32 v66, v20, v21
    v_exp_f32 v23, v23
    v_exp_f32 v24, v24
    v_cvt_pk_bf16_f32 v67, v22, v23
    v_exp_f32 v25, v25
    v_exp_f32 v26, v26
    v_mfma_f32_32x32x16_bf16 v[112:127], a[48:51], v[64:67], v[112:127]
    v_cvt_pk_bf16_f32 v68, v24, v25
    v_exp_f32 v27, v27
    v_exp_f32 v28, v28
    v_cvt_pk_bf16_f32 v69, v26, v27
    s_waitcnt lgkmcnt(0)
    v_mfma_f32_32x32x16_bf16 v[128:143], v[184:187], v[164:167], v[128:143]
    v_exp_f32 v29, v29
    v_exp_f32 v30, v30
    v_cvt_pk_bf16_f32 v70, v28, v29
    v_exp_f32 v31, v31
    s_cmp_eq_u32 s60, 0
    s_cbranch_scc1 SLOWC_I7
    ds_read_b32 v16, v13 offset:0
    ds_read_b32 v17, v13 offset:1024
    ds_read_b32 v18, v13 offset:2048
    ds_read_b32 v19, v13 offset:3072
    s_waitcnt lgkmcnt(0)
    v_max_f32 v16, v16, v17
    v_max_f32 v16, v16, v18
    v_max_f32 v16, v16, v19
    v_sub_f32 v16, 0, v16
    s_nop 7
    v_mov_b32 v48, v16
    v_mov_b32 v49, v16
    v_mov_b32 v50, v16
    v_mov_b32 v51, v16
    v_mov_b32 v52, v16
    v_mov_b32 v53, v16
    v_mov_b32 v54, v16
    v_mov_b32 v55, v16
    v_mov_b32 v56, v16
    v_mov_b32 v57, v16
    v_mov_b32 v58, v16
    v_mov_b32 v59, v16
    v_mov_b32 v60, v16
    v_mov_b32 v61, v16
    v_mov_b32 v62, v16
    v_mov_b32 v63, v16
    s_nop 1
SLOWC_I7:
    v_exp_f32 v32, v32
    s_waitcnt vmcnt(9)
    v_cvt_pk_bf16_f32 v71, v30, v31
    v_exp_f32 v33, v33
    v_exp_f32 v34, v34
    v_mfma_f32_32x32x16_bf16 v[112:127], a[52:55], v[68:71], v[112:127]
    v_cvt_pk_bf16_f32 v64, v32, v33
    v_exp_f32 v35, v35
    s_add_u32 m0, s66, 2048
    s_add_u32 s50, s73, 16384
    buffer_load_dwordx4 v7, s[44:47], s50 offen lds
    v_exp_f32 v36, v36
    v_cvt_pk_bf16_f32 v65, v34, v35
    v_mfma_f32_32x32x16_bf16 v[16:31], v[80:83], v[72:75], v[48:63]
    v_exp_f32 v37, v37
    v_exp_f32 v38, v38
    s_add_u32 m0, s66, 3072
    s_add_u32 s50, s74, 16384
    buffer_load_dwordx4 v7, s[44:47], s50 offen lds
    v_cvt_pk_bf16_f32 v66, v36, v37
    v_exp_f32 v39, v39
    v_exp_f32 v40, v40
    v_cvt_pk_bf16_f32 v67, v38, v39
    v_exp_f32 v41, v41
    v_exp_f32 v42, v42
    v_mfma_f32_32x32x16_bf16 v[112:127], a[56:59], v[64:67], v[112:127]
    v_cvt_pk_bf16_f32 v68, v40, v41
    v_exp_f32 v43, v43
    v_exp_f32 v44, v44
    v_cvt_pk_bf16_f32 v69, v42, v43
    v_mfma_f32_32x32x16_bf16 v[144:159], v[188:191], v[164:167], v[144:159]
    v_exp_f32 v45, v45
    v_exp_f32 v46, v46
    v_cvt_pk_bf16_f32 v70, v44, v45
    v_exp_f32 v47, v47
    s_nop 0
    v_cvt_pk_bf16_f32 v71, v46, v47
    s_waitcnt lgkmcnt(0)
    s_nop 0
    v_mfma_f32_32x32x16_bf16 v[112:127], a[60:63], v[68:71], v[112:127]
    s_and_b32 s49, s24, 1
    s_lshl_b32 s49, s49, 13
    v_subrev_u32 v8, s49, v8
    v_subrev_u32 v9, s49, v9
    s_nop 7
    ds_write_b128 v6, v[112:115] offset:6912
    ds_write_b128 v6, v[116:119] offset:7936
    ds_write_b32 v0, v120 offset:8960
    s_waitcnt lgkmcnt(0)
    s_barrier
    s_mul_i32 s48, s24, 2304
    v_add_u32 v3, s48, v2
    v_lshlrev_b32 v4, 2, v1
    v_add_u32 v4, s48, v4
    ds_read_b128 v[16:19], v3 offset:0
    ds_read_b128 v[20:23], v3 offset:1024
    ds_read_b32 v24, v4 offset:2048
    ds_read_b128 v[28:31], v3 offset:18432
    ds_read_b128 v[32:35], v3 offset:19456
    ds_read_b32 v36, v4 offset:20480
    ds_read_b128 v[40:43], v3 offset:36864
    ds_read_b128 v[44:47], v3 offset:37888
    ds_read_b32 v48, v4 offset:38912
    ds_read_b128 v[52:55], v3 offset:55296
    ds_read_b128 v[56:59], v3 offset:56320
    ds_read_b32 v60, v4 offset:57344
    s_lshl_b32 s48, s58, 3
    s_add_u32 s48, s48, s24
    s_lshl_b32 s48, s48, 5
    s_add_u32 s48, s48, s57
    s_lshl_b32 s48, s48, 10
    s_add_u32 s48, s48, 0x600000
    s_waitcnt lgkmcnt(0)
    v_add_f32 v16, v16, v28
    v_add_f32 v40, v40, v52
    v_add_f32 v17, v17, v29
    v_add_f32 v41, v41, v53
    v_add_f32 v18, v18, v30
    v_add_f32 v42, v42, v54
    v_add_f32 v19, v19, v31
    v_add_f32 v43, v43, v55
    v_add_f32 v20, v20, v32
    v_add_f32 v44, v44, v56
    v_add_f32 v21, v21, v33
    v_add_f32 v45, v45, v57
    v_add_f32 v22, v22, v34
    v_add_f32 v46, v46, v58
    v_add_f32 v23, v23, v35
    v_add_f32 v47, v47, v59
    v_add_f32 v24, v24, v36
    v_add_f32 v48, v48, v60
    v_add_f32 v16, v16, v40
    v_add_f32 v17, v17, v41
    v_add_f32 v18, v18, v42
    v_add_f32 v19, v19, v43
    v_add_f32 v20, v20, v44
    v_add_f32 v21, v21, v45
    v_add_f32 v22, v22, v46
    v_add_f32 v23, v23, v47
    v_add_f32 v24, v24, v48
    v_mov_b32 v25, v24
    s_nop 1
    v_permlane32_swap_b32 v24, v25
    s_nop 1
    v_rcp_f32 v24, v24
    s_nop 0
    v_mul_f32 v16, v16, v24
    v_mul_f32 v17, v17, v24
    v_mul_f32 v18, v18, v24
    v_mul_f32 v19, v19, v24
    v_mul_f32 v20, v20, v24
    v_mul_f32 v21, v21, v24
    v_mul_f32 v22, v22, v24
    v_mul_f32 v23, v23, v24
    v_cvt_pk_bf16_f32 v64, v16, v17
    v_cvt_pk_bf16_f32 v65, v18, v19
    v_cvt_pk_bf16_f32 v66, v20, v21
    v_cvt_pk_bf16_f32 v67, v22, v23
    buffer_store_dwordx4 v[64:67], v2, s[20:23], s48 offen sc1
    s_waitcnt vmcnt(0)
    s_lshl_b32 s48, s58, 2
    s_lshr_b32 s49, s24, 1
    s_add_u32 s48, s48, s49
    s_lshl_b32 s48, s48, 8
    s_lshl_b32 s49, s57, 1
    s_and_b32 s50, s24, 1
    s_add_u32 s49, s49, s50
    s_lshl_b32 s49, s49, 2
    s_add_u32 s48, s48, s49
    s_add_u32 s48, s48, 0xe13000
    v_mov_b32 v3, s56
    v_mov_b32 v4, 0
    s_mov_b64 exec, 1
    buffer_store_dword v3, v4, s[20:23], s48 offen sc1
    s_mov_b64 exec, -1
    s_barrier
    ds_read_b64_tr_b16 v[32:33], v8 offset:0
    ds_read_b64_tr_b16 v[34:35], v8 offset:1024
    ds_read_b64_tr_b16 v[36:37], v9 offset:0
    ds_read_b64_tr_b16 v[38:39], v9 offset:1024
    ds_read_b64_tr_b16 v[40:41], v8 offset:2048
    ds_read_b64_tr_b16 v[42:43], v8 offset:3072
    ds_read_b64_tr_b16 v[44:45], v9 offset:2048
    ds_read_b64_tr_b16 v[46:47], v9 offset:3072
    ds_read_b64_tr_b16 v[48:49], v8 offset:4096
    ds_read_b64_tr_b16 v[50:51], v8 offset:5120
    ds_read_b64_tr_b16 v[52:53], v9 offset:4096
    ds_read_b64_tr_b16 v[54:55], v9 offset:5120
    s_waitcnt lgkmcnt(0)
    ds_read_b64_tr_b16 v[56:57], v8 offset:6144
    ds_read_b64_tr_b16 v[58:59], v8 offset:7168
    ds_read_b64_tr_b16 v[60:61], v9 offset:6144
    ds_read_b64_tr_b16 v[62:63], v9 offset:7168
    ds_read_b64_tr_b16 v[64:65], v8 offset:8192
    ds_read_b64_tr_b16 v[66:67], v8 offset:9216
    ds_read_b64_tr_b16 v[68:69], v9 offset:8192
    ds_read_b64_tr_b16 v[70:71], v9 offset:9216
    ds_read_b64_tr_b16 v[72:73], v8 offset:10240
    ds_read_b64_tr_b16 v[74:75], v8 offset:11264
    ds_read_b64_tr_b16 v[76:77], v9 offset:10240
    ds_read_b64_tr_b16 v[78:79], v9 offset:11264
    s_waitcnt lgkmcnt(0)
    ds_read_b64_tr_b16 v[80:81], v8 offset:12288
    ds_read_b64_tr_b16 v[82:83], v8 offset:13312
    ds_read_b64_tr_b16 v[84:85], v9 offset:12288
    ds_read_b64_tr_b16 v[86:87], v9 offset:13312
    ds_read_b64_tr_b16 v[88:89], v8 offset:14336
    ds_read_b64_tr_b16 v[90:91], v8 offset:15360
    ds_read_b64_tr_b16 v[92:93], v9 offset:14336
    ds_read_b64_tr_b16 v[94:95], v9 offset:15360
    v_sub_f32 v15, 1.0, v14
    v_mul_f32 v128, v15, v128
    v_mul_f32 v129, v15, v129
    v_mul_f32 v130, v15, v130
    v_mul_f32 v131, v15, v131
    v_mul_f32 v132, v15, v132
    v_mul_f32 v133, v15, v133
    v_mul_f32 v134, v15, v134
    v_mul_f32 v135, v15, v135
    v_mul_f32 v136, v15, v136
    v_mul_f32 v137, v15, v137
    v_mul_f32 v138, v15, v138
    v_mul_f32 v139, v15, v139
    v_mul_f32 v140, v15, v140
    v_mul_f32 v141, v15, v141
    v_mul_f32 v142, v15, v142
    v_mul_f32 v143, v15, v143
    v_mul_f32 v144, v15, v144
    v_mul_f32 v145, v15, v145
    v_mul_f32 v146, v15, v146
    v_mul_f32 v147, v15, v147
    v_mul_f32 v148, v15, v148
    v_mul_f32 v149, v15, v149
    v_mul_f32 v150, v15, v150
    v_mul_f32 v151, v15, v151
    v_mul_f32 v152, v15, v152
    v_mul_f32 v153, v15, v153
    v_mul_f32 v154, v15, v154
    v_mul_f32 v155, v15, v155
    v_mul_f32 v156, v15, v156
    v_mul_f32 v157, v15, v157
    v_mul_f32 v158, v15, v158
    v_mul_f32 v159, v15, v159
    s_waitcnt lgkmcnt(0)
    s_cmp_lg_u32 s24, 0
    s_cbranch_scc1 S3_SKIP
    s_lshr_b32 s48, s70, 0
    s_lshl_b32 s48, s48, 8
    s_add_u32 s48, s48, 0xe13000
    v_and_b32 v4, 63, v1
    v_lshlrev_b32 v4, 2, v4
    s_mov_b32 s61, 0
POLL_L3:
    buffer_load_dword v3, v4, s[20:23], s48 offen sc1
    s_waitcnt vmcnt(0)
    v_cmp_ne_u32 vcc, s56, v3
    s_add_u32 s61, s61, 1
    s_cmp_gt_u32 s61, 400000
    s_cbranch_scc1 POLL_D3
    s_cmp_eq_u64 vcc, 0
    s_cbranch_scc1 POLL_D3
    s_sleep 2
    s_branch POLL_L3
POLL_D3:
S3_SKIP:
    s_barrier
    s_lshl_b32 s48, s70, 1
    s_and_b32 s49, s24, 1
    s_add_u32 s48, s48, s49
    s_lshl_b32 s72, s48, 15
    s_lshr_b32 s49, s24, 1
    s_lshl_b32 s49, s49, 13
    s_add_u32 s72, s72, s49
    s_add_u32 s72, s72, 0x600000
    buffer_load_dwordx4 v[96:99], v2, s[20:23], s72 offen offset:0 sc1
    buffer_load_dwordx4 v[100:103], v2, s[20:23], s72 offen offset:1024 sc1
    buffer_load_dwordx4 v[104:107], v2, s[20:23], s72 offen offset:2048 sc1
    buffer_load_dwordx4 v[108:111], v2, s[20:23], s72 offen offset:3072 sc1
    s_add_u32 s72, s72, 4096
    buffer_load_dwordx4 v[112:115], v2, s[20:23], s72 offen offset:0 sc1
    buffer_load_dwordx4 v[116:119], v2, s[20:23], s72 offen offset:1024 sc1
    buffer_load_dwordx4 v[120:123], v2, s[20:23], s72 offen offset:2048 sc1
    buffer_load_dwordx4 v[124:127], v2, s[20:23], s72 offen offset:3072 sc1
    s_waitcnt vmcnt(7)
    v_mfma_f32_32x32x16_bf16 v[160:175], v[32:35], v[96:99], 0
    v_mfma_f32_32x32x16_bf16 v[176:191], v[36:39], v[96:99], 0
    s_waitcnt vmcnt(6)
    v_mfma_f32_32x32x16_bf16 v[160:175], v[40:43], v[100:103], v[160:175]
    v_mfma_f32_32x32x16_bf16 v[176:191], v[44:47], v[100:103], v[176:191]
    s_waitcnt vmcnt(5)
    v_mfma_f32_32x32x16_bf16 v[160:175], v[48:51], v[104:107], v[160:175]
    v_mfma_f32_32x32x16_bf16 v[176:191], v[52:55], v[104:107], v[176:191]
    s_waitcnt vmcnt(4)
    v_mfma_f32_32x32x16_bf16 v[160:175], v[56:59], v[108:111], v[160:175]
    v_mfma_f32_32x32x16_bf16 v[176:191], v[60:63], v[108:111], v[176:191]
    s_waitcnt vmcnt(3)
    v_mfma_f32_32x32x16_bf16 v[160:175], v[64:67], v[112:115], v[160:175]
    v_mfma_f32_32x32x16_bf16 v[176:191], v[68:71], v[112:115], v[176:191]
    s_waitcnt vmcnt(2)
    v_mfma_f32_32x32x16_bf16 v[160:175], v[72:75], v[116:119], v[160:175]
    v_mfma_f32_32x32x16_bf16 v[176:191], v[76:79], v[116:119], v[176:191]
    s_waitcnt vmcnt(1)
    v_mfma_f32_32x32x16_bf16 v[160:175], v[80:83], v[120:123], v[160:175]
    v_mfma_f32_32x32x16_bf16 v[176:191], v[84:87], v[120:123], v[176:191]
    s_waitcnt vmcnt(0)
    v_mfma_f32_32x32x16_bf16 v[160:175], v[88:91], v[124:127], v[160:175]
    v_mfma_f32_32x32x16_bf16 v[176:191], v[92:95], v[124:127], v[176:191]
    s_lshl_b32 s48, s24, 13
    s_nop 7
    s_nop 3
    v_fmac_f32 v128, v14, v160
    v_fmac_f32 v129, v14, v161
    v_fmac_f32 v130, v14, v162
    v_fmac_f32 v131, v14, v163
    v_fmac_f32 v132, v14, v164
    v_fmac_f32 v133, v14, v165
    v_fmac_f32 v134, v14, v166
    v_fmac_f32 v135, v14, v167
    v_fmac_f32 v136, v14, v168
    v_fmac_f32 v137, v14, v169
    v_fmac_f32 v138, v14, v170
    v_fmac_f32 v139, v14, v171
    v_fmac_f32 v140, v14, v172
    v_fmac_f32 v141, v14, v173
    v_fmac_f32 v142, v14, v174
    v_fmac_f32 v143, v14, v175
    v_fmac_f32 v144, v14, v176
    v_fmac_f32 v145, v14, v177
    v_fmac_f32 v146, v14, v178
    v_fmac_f32 v147, v14, v179
    v_fmac_f32 v148, v14, v180
    v_fmac_f32 v149, v14, v181
    v_fmac_f32 v150, v14, v182
    v_fmac_f32 v151, v14, v183
    v_fmac_f32 v152, v14, v184
    v_fmac_f32 v153, v14, v185
    v_fmac_f32 v154, v14, v186
    v_fmac_f32 v155, v14, v187
    v_fmac_f32 v156, v14, v188
    v_fmac_f32 v157, v14, v189
    v_fmac_f32 v158, v14, v190
    v_fmac_f32 v159, v14, v191
    s_lshl_b32 s48, s24, 13
    s_add_u32 s48, s48, 73728
    v_add_u32 v3, s48, v2
    ds_write_b128 v3, v[128:131] offset:0
    ds_write_b128 v3, v[132:135] offset:1024
    ds_write_b128 v3, v[136:139] offset:2048
    ds_write_b128 v3, v[140:143] offset:3072
    ds_write_b128 v3, v[144:147] offset:4096
    ds_write_b128 v3, v[148:151] offset:5120
    ds_write_b128 v3, v[152:155] offset:6144
    ds_write_b128 v3, v[156:159] offset:7168
    s_waitcnt lgkmcnt(0)
    s_barrier
    s_and_b32 s48, s24, 1
    s_lshl_b32 s48, s48, 13
    s_lshr_b32 s49, s24, 1
    s_and_b32 s49, s49, 1
    s_lshl_b32 s50, s49, 12
    s_add_u32 s48, s48, s50
    s_lshr_b32 s50, s24, 2
    s_lshl_b32 s51, s50, 11
    s_add_u32 s48, s48, s51
    s_add_u32 s48, s48, 73728
    v_add_u32 v3, s48, v2
    ds_read_b128 v[32:35], v3 offset:0
    ds_read_b128 v[36:39], v3 offset:1024
    ds_read_b128 v[40:43], v3 offset:16384
    ds_read_b128 v[44:47], v3 offset:17408
    ds_read_b128 v[48:51], v3 offset:32768
    ds_read_b128 v[52:55], v3 offset:33792
    ds_read_b128 v[56:59], v3 offset:49152
    ds_read_b128 v[60:63], v3 offset:50176
    v_and_b32 v4, 31, v1
    v_lshlrev_b32 v4, 10, v4
    v_lshrrev_b32 v5, 5, v1
    v_lshlrev_b32 v5, 4, v5
    v_add_u32 v4, v4, v5
    s_lshl_b32 s48, s70, 16
    s_and_b32 s51, s24, 1
    s_lshl_b32 s51, s51, 15
    s_add_u32 s48, s48, s51
    s_lshl_b32 s51, s71, 7
    s_add_u32 s48, s48, s51
    s_lshl_b32 s49, s49, 6
    s_add_u32 s48, s48, s49
    s_lshl_b32 s50, s50, 5
    s_add_u32 s48, s48, s50
    s_waitcnt lgkmcnt(0)
    v_add_f32 v32, v32, v40
    v_add_f32 v48, v48, v56
    v_add_f32 v33, v33, v41
    v_add_f32 v49, v49, v57
    v_add_f32 v34, v34, v42
    v_add_f32 v50, v50, v58
    v_add_f32 v35, v35, v43
    v_add_f32 v51, v51, v59
    v_add_f32 v36, v36, v44
    v_add_f32 v52, v52, v60
    v_add_f32 v37, v37, v45
    v_add_f32 v53, v53, v61
    v_add_f32 v38, v38, v46
    v_add_f32 v54, v54, v62
    v_add_f32 v39, v39, v47
    v_add_f32 v55, v55, v63
    v_add_f32 v32, v32, v48
    v_add_f32 v33, v33, v49
    v_add_f32 v34, v34, v50
    v_add_f32 v35, v35, v51
    v_add_f32 v36, v36, v52
    v_add_f32 v37, v37, v53
    v_add_f32 v38, v38, v54
    v_add_f32 v39, v39, v55
    v_cvt_pk_bf16_f32 v64, v32, v33
    v_cvt_pk_bf16_f32 v65, v34, v35
    v_cvt_pk_bf16_f32 v66, v36, v37
    v_cvt_pk_bf16_f32 v67, v38, v39
    s_nop 1
    v_permlane32_swap_b32 v64, v66
    v_permlane32_swap_b32 v65, v67
    buffer_store_dwordx4 v[64:67], v4, s[16:19], s48 offen
K_END:
    s_endpgm
S2_SPIN:
    s_mov_b32 s61, 0
S2_SPIN_L:
    buffer_load_dword v10, v11, s[20:23], s75 offen sc1
    s_waitcnt vmcnt(0)
    v_cmp_ne_u32 vcc, s56, v10
    s_add_u32 s61, s61, 1
    s_nop 3
    s_and_b32 vcc_lo, vcc_lo, 0x3fffffff
    s_and_b32 vcc_hi, vcc_hi, 0x3fffffff
    s_cmp_gt_u32 s61, 400000
    s_cbranch_scc1 S2_SPIN_D
    s_cmp_eq_u64 vcc, 0
    s_cbranch_scc1 S2_SPIN_D
    s_sleep 4
    s_branch S2_SPIN_L
S2_SPIN_D:
    s_setpc_b64 s[0:1]
FG_SPIN:
    s_mov_b32 s61, 0
FG_SPIN_L:
    buffer_load_dword v10, v11, s[20:23], s75 offen sc1
    s_waitcnt vmcnt(0)
    v_cmp_ne_u32 vcc, s56, v10
    s_add_u32 s61, s61, 1
    s_nop 3
    s_cmp_gt_u32 s61, 400000
    s_cbranch_scc1 FG_SPIN_D
    s_cmp_eq_u64 vcc, 0
    s_cbranch_scc1 FG_SPIN_D
    s_sleep 4
    s_branch FG_SPIN_L
FG_SPIN_D:
    s_setpc_b64 s[0:1]
    s_endpgm
K_CODE_END:
.set CODE_BYTES, K_CODE_END - gated_mix__mha_block__glu_gated_geglu__prompt_kernel
.section .rodata,"a"
.p2align 6
.amdhsa_kernel gated_mix__mha_block__glu_gated_geglu__prompt_kernel
  .amdhsa_next_free_vgpr 256
  .amdhsa_next_free_sgpr 102
  .amdhsa_accum_offset 192
  .amdhsa_group_segment_fixed_size 0
  .amdhsa_kernarg_size 88
  .amdhsa_user_sgpr_count 2
  .amdhsa_user_sgpr_kernarg_segment_ptr 1
  .amdhsa_system_sgpr_workgroup_id_x 1
  .amdhsa_float_denorm_mode_32 3
  .amdhsa_float_denorm_mode_16_64 3
.end_amdhsa_kernel
```
